```python
import torch

def _softmax(x, axis=-1):
    return torch.softmax(x, dim=axis)
def _gelu(x):
    return torch.nn.functional.gelu(x, approximate="tanh")
def _silu(x):
    return torch.nn.functional.silu(x)
def _sigmoid(x):
    return torch.sigmoid(x)
def _layernorm(x, axis=-1, eps=1e-5):
    m = x.mean(dim=axis, keepdim=True)
    v = x.var(dim=axis, keepdim=True, unbiased=False)
    return (x - m) / torch.sqrt(v + eps)
def _scatter_add(tgt, idx, src, axis=0):
    return tgt.clone().index_add_(axis, idx, src)
def _segment_sum(src, seg, n):
    out = torch.zeros((n,) + src.shape[1:], dtype=src.dtype)
    return out.index_add_(0, seg, src)
def _pad(x, pw):
    flat = tuple(v for pair in reversed(pw) for v in pair)
    return torch.nn.functional.pad(x, flat)

kernel_name = 'gated_mix__ssm_conv_h3__grouped_kv_mqa__prompt'

def setup_inputs():

    _w = (lambda a: (lambda t: t.to(torch.bfloat16) if t.is_floating_point() else t)(torch.as_tensor(a)))
    def _A_setup():
        B, S, D = 1, 2048, 512
        ks = 4
        return {
            "q": _w((lambda *s: torch.randn(*s, dtype=torch.bfloat16) * 0.05)(B, S, D)),
            "k": _w((lambda *s: torch.randn(*s, dtype=torch.bfloat16) * 0.2)(B, S, D)),
            "v": _w((lambda *s: torch.randn(*s, dtype=torch.bfloat16) * 0.2)(B, S, D)),
            "shift_k": _w((lambda *s: torch.randn(*s, dtype=torch.bfloat16) * 0.2)(D, ks) * 0.5),
            "ssm_k": _w((lambda *s: torch.randn(*s, dtype=torch.bfloat16) * 0.8)(D, S) * (1.0 / S ** 0.5)),
            "ssm_D": _w((lambda *s: torch.randn(*s, dtype=torch.bfloat16) * 0.2)(D)),
        }
    _A_in = _A_setup()

    def _B_setup():
        B, S, D, H = 1, 2048, 512, 32
        Dh = D // H
        return {
            "x": _w((lambda *s: torch.randn(*s, dtype=torch.bfloat16) * 0.05)(B, S, D)),
            "wq": _w((lambda *s: torch.randn(*s, dtype=torch.bfloat16) * 0.8)(D, H * Dh)),
            "wk": _w((lambda *s: torch.randn(*s, dtype=torch.bfloat16) * 0.8)(D, Dh)),
            "wv": _w((lambda *s: torch.randn(*s, dtype=torch.bfloat16) * 0.05)(D, Dh)),
            "wo": _w((lambda *s: torch.randn(*s, dtype=torch.bfloat16) * 0.05)(H * Dh, D)),
        }
    _B_in = _B_setup()

    return {
        "A_q": _A_in["q"],
        "A_k": _A_in["k"],
        "A_v": _A_in["v"],
        "A_shift_k": _A_in["shift_k"],
        "A_ssm_k": _A_in["ssm_k"],
        "A_ssm_D": _A_in["ssm_D"],
        "B_x": _B_in["x"],
        "B_wq": _B_in["wq"],
        "B_wk": _B_in["wk"],
        "B_wv": _B_in["wv"],
        "B_wo": _B_in["wo"],
        "gate_w": _w((lambda *s: torch.randn(*s, dtype=torch.bfloat16) * 0.05)(512) * 16.0),
    }

def reference(A_q, A_k, A_v, A_shift_k, A_ssm_k, A_ssm_D, B_x, B_wq, B_wk, B_wv, B_wo, gate_w):
    def _A_ref(q, k, v, shift_k, ssm_k, ssm_D):
        B, S, D = q.shape
        ks = shift_k.shape[-1]
        k_pad = _pad(k, ((0, 0), (ks - 1, 0), (0, 0)))
        k_shift = torch.zeros_like(k)
        for t in range(ks):
            k_shift = k_shift + k_pad[:, t:t + S, :] * shift_k[:, ks - 1 - t][None, None, :]
        kv = k_shift * v
        L = 2 * S
        kv_pad = _pad(kv, ((0, 0), (0, S), (0, 0)))
        kf_pad = _pad(ssm_k, ((0, 0), (0, S)))
        kv_f = (lambda x, axes=(-2,-1): torch.fft.rfft2(x.float(), dim=axes))(kv_pad[:, None, :, :], axes=(1, 2))
        kf_f = (lambda x, axes=(-2,-1): torch.fft.rfft2(x.float(), dim=axes))(kf_pad[:, None, :], axes=(1, 2))
        kf_f = (lambda x, *d: x.permute(*d))(kf_f, 1, 2, 0)
        y_f = kv_f * kf_f[None, :, :, :]
        y = (lambda x, s, axes=(-2,-1): torch.fft.irfft2(x, s=s, dim=axes).to(torch.bfloat16))(y_f, (1, L), axes=(1, 2))[:, 0, :S, :]
        y = y + kv * ssm_D[None, None, :]
        return q * y

    def _B_ref(x, wq, wk, wv, wo):
        B, S, D = x.shape
        H = 32
        Dh = D // H
        q = (lambda x, *d: x.permute(*d))((x @ wq).reshape(B, S, H, Dh), 0, 2, 1, 3)
        k = x @ wk
        v = x @ wv
        scores = torch.einsum("bhqd,bkd->bhqk", q, k) * (Dh ** -0.5)
        p = _softmax(scores, axis=-1)
        o = torch.einsum("bhqk,bkd->bhqd", p, v)
        return (lambda x, *d: x.permute(*d))(o, 0, 2, 1, 3).reshape(B, S, H * Dh) @ wo

    x = A_q
    g = _sigmoid((x * gate_w).sum(-1, keepdims=True))
    a = _A_ref(x, A_k, A_v, A_shift_k, A_ssm_k, A_ssm_D)
    b = _B_ref(x, B_wq, B_wk, B_wv, B_wo)
    return g * a + (1 - g) * b
```

```asm
; @launch grid=(256,1,1) block=(768,1,1) lds=163840
.amdgcn_target "amdgcn-amd-amdhsa--gfx950"
.text
.globl gated_mix__ssm_conv_h3__grouped_kv_mqa__prompt_kernel
.p2align 8
.type gated_mix__ssm_conv_h3__grouped_kv_mqa__prompt_kernel,@function
gated_mix__ssm_conv_h3__grouped_kv_mqa__prompt_kernel:
    s_getpc_b64 s[36:37]
    s_load_dwordx16 s[4:19], s[0:1], 0
    s_load_dwordx16 s[20:35], s[0:1], 56
    v_lshlrev_b32 v1, 7, v0
    v_min_u32 v1, code_end-gated_mix__ssm_conv_h3__grouped_kv_mqa__prompt_kernel-8, v1
    global_load_dword v167, v1, s[36:37]
    s_cmp_ge_u32 s2, 256
    s_cbranch_scc1 k_end
    v_lshrrev_b32 v2, 6, v0
    v_and_b32 v1, 63, v0
    v_readfirstlane_b32 s3, v2
    s_and_b32 s60, s2, 7
    s_lshl_b32 s60, s60, 2
    s_lshr_b32 s61, s2, 3
    s_and_b32 s62, s61, 3
    s_add_u32 s60, s60, s62
    s_lshr_b32 s61, s61, 2
    s_lshl_b32 s56, s60, 6
    s_lshl_b32 s57, s61, 6
    s_add_u32 s59, s61, s62
    s_add_u32 s59, s59, s2
    s_and_b32 s59, s59, 3
    s_lshr_b32 s76, s61, 1
    s_lshl_b32 s58, s62, 1
    v_lshlrev_b32 v2, 4, v1
    s_cmp_lt_u32 s3, 8
    s_cbranch_scc1 e_att
    s_sub_u32 s66, s3, 8
    v_lshrrev_b32 v9, 4, v1
    v_and_b32 v10, 15, v1
    v_xor_b32 v10, v10, v9
    v_lshlrev_b32 v10, 4, v10
    v_lshl_add_u32 v4, v9, 10, v10
    v_xor_b32 v5, 64, v4
    v_xor_b32 v6, 0x80, v4
    v_xor_b32 v7, 0xc0, v4
    v_add_u32 v5, 3072, v5
    v_add_u32 v6, 6144, v6
    v_add_u32 v7, 9216, v7
    s_add_u32 s63, s59, s66
    s_and_b32 s63, s63, 3
    s_lshl_b32 s64, s76, 4
    s_add_u32 s64, s64, s56
    s_lshl_b32 s64, s64, 10
    s_lshl_b32 s65, s63, 8
    s_add_u32 s64, s64, s65
    s_lshl_b32 s65, s63, 12
    s_lshl_b32 s67, s66, 14
    s_lshl_b32 s68, s76, 12
    s_add_u32 m0, s67, s68
    s_lshl_b32 s68, s66, 12
    s_add_u32 s67, s68, 131072
    s_mov_b32 s38, 0x200000
    s_mov_b32 s39, 0x20000
    s_mov_b32 s42, 0x4000
    s_mov_b32 s43, 0x20000
    s_bitcmp0_b32 s61, 0
    s_waitcnt lgkmcnt(0)
    s_mov_b32 s36, s4
    s_mov_b32 s37, s5
    buffer_load_dwordx4 v4, s[36:39], s64 offen offset:0 lds
    buffer_load_dwordx4 v5, s[36:39], s64 offen offset:1024 lds
    buffer_load_dwordx4 v6, s[36:39], s64 offen offset:2048 lds
    buffer_load_dwordx4 v7, s[36:39], s64 offen offset:3072 lds
    s_cselect_b32 s40, s22, s24
    s_cselect_b32 s41, s23, s25
    s_mov_b32 m0, s67
    s_nop 0
    buffer_load_dwordx4 v2, s[40:43], s65 offen offset:0 lds
    buffer_load_dwordx4 v2, s[40:43], s65 offen offset:1024 lds
    buffer_load_dwordx4 v2, s[40:43], s65 offen offset:2048 lds
    buffer_load_dwordx4 v2, s[40:43], s65 offen offset:3072 lds
    s_mov_b32 s44, s18
    s_mov_b32 s45, s19
    s_mov_b32 s46, 524288
    s_mov_b32 s47, 0x20000
    v_lshrrev_b32 v9, 3, v1
    v_lshlrev_b32 v10, 1, v9
    v_and_b32 v10, 4, v10
    v_and_b32 v8, 7, v1
    v_xor_b32 v8, v8, v10
    v_lshlrev_b32 v8, 4, v8
    v_lshl_add_u32 v8, v9, 10, v8
    s_lshl_b32 s63, s57, 1
    v_add_u32 v8, s63, v8
    v_add_u32 v9, 7168, v8
    v_add_u32 v10, 14336, v8
    v_add_u32 v11, 21504, v8
    s_lshl_b32 s63, s66, 6
    v_xor_b32 v13, s63, v4
    s_lshl_b32 s63, s66, 12
    v_add_u32 v13, s63, v13
    s_lshl_b32 s69, s66, 15
    s_lshl_b32 s64, s56, 10
    s_lshl_b32 s65, s66, 10
    s_add_u32 s63, s76, 1
    s_and_b32 s63, s63, 3
    s_lshl_b32 s48, s63, 14
    s_add_u32 s48, s48, s64
    s_lshl_b32 s52, s63, 12
    s_add_u32 s52, s52, s65
    s_add_u32 s63, s76, 2
    s_and_b32 s63, s63, 3
    s_lshl_b32 s49, s63, 14
    s_add_u32 s49, s49, s64
    s_lshl_b32 s53, s63, 12
    s_add_u32 s53, s53, s65
    s_add_u32 s63, s76, 3
    s_and_b32 s63, s63, 3
    s_lshl_b32 s50, s63, 14
    s_add_u32 s50, s50, s64
    s_lshl_b32 s54, s63, 12
    s_add_u32 s54, s54, s65
    s_add_u32 s63, s59, 0
    s_and_b32 s63, s63, 3
    s_lshl_b32 s67, s63, 17
    s_add_u32 s67, s67, s69
    s_lshl_b32 s65, s63, 8
    s_add_u32 m0, s68, 65536
    s_nop 0
    buffer_load_dwordx4 v8, s[44:47], s67 offen offset:0 lds
    buffer_load_dwordx4 v9, s[44:47], s67 offen offset:1024 lds
    buffer_load_dwordx4 v10, s[44:47], s67 offen offset:2048 lds
    buffer_load_dwordx4 v11, s[44:47], s67 offen offset:3072 lds
    s_add_u32 m0, s52, 0
    s_add_u32 s64, s48, s65
    buffer_load_dwordx4 v13, s[36:39], s64 offen lds
    s_add_u32 m0, s53, 0
    s_add_u32 s64, s49, s65
    buffer_load_dwordx4 v13, s[36:39], s64 offen lds
    s_add_u32 m0, s54, 0
    s_add_u32 s64, s50, s65
    buffer_load_dwordx4 v13, s[36:39], s64 offen lds
    v_mov_b32 v3, 149760
    v_lshl_add_u32 v14, v1, 2, v3
    v_mov_b32 v12, 0
    s_mov_b64 exec, 0xffff
    ds_write_b32 v14, v12
    s_mov_b64 exec, -1
    v_mov_b32 v14, 1
    s_waitcnt vmcnt(7) lgkmcnt(0)
    s_barrier
    s_add_u32 s63, s59, 1
    s_and_b32 s63, s63, 3
    s_lshl_b32 s67, s63, 17
    s_add_u32 s67, s67, s69
    s_lshl_b32 s65, s63, 8
    s_add_u32 m0, s68, 81920
    s_nop 0
    buffer_load_dwordx4 v8, s[44:47], s67 offen offset:0 lds
    buffer_load_dwordx4 v9, s[44:47], s67 offen offset:1024 lds
    buffer_load_dwordx4 v10, s[44:47], s67 offen offset:2048 lds
    buffer_load_dwordx4 v11, s[44:47], s67 offen offset:3072 lds
    s_add_u32 m0, s52, 16384
    s_add_u32 s64, s48, s65
    buffer_load_dwordx4 v13, s[36:39], s64 offen lds
    s_add_u32 m0, s53, 16384
    s_add_u32 s64, s49, s65
    buffer_load_dwordx4 v13, s[36:39], s64 offen lds
    s_add_u32 m0, s54, 16384
    s_add_u32 s64, s50, s65
    buffer_load_dwordx4 v13, s[36:39], s64 offen lds
    s_add_u32 s63, s59, 2
    s_and_b32 s63, s63, 3
    s_lshl_b32 s67, s63, 17
    s_add_u32 s67, s67, s69
    s_lshl_b32 s65, s63, 8
    s_add_u32 m0, s68, 98304
    s_nop 0
    buffer_load_dwordx4 v8, s[44:47], s67 offen offset:0 lds
    buffer_load_dwordx4 v9, s[44:47], s67 offen offset:1024 lds
    buffer_load_dwordx4 v10, s[44:47], s67 offen offset:2048 lds
    buffer_load_dwordx4 v11, s[44:47], s67 offen offset:3072 lds
    s_add_u32 m0, s52, 32768
    s_add_u32 s64, s48, s65
    buffer_load_dwordx4 v13, s[36:39], s64 offen lds
    s_add_u32 m0, s53, 32768
    s_add_u32 s64, s49, s65
    buffer_load_dwordx4 v13, s[36:39], s64 offen lds
    s_add_u32 m0, s54, 32768
    s_add_u32 s64, s50, s65
    buffer_load_dwordx4 v13, s[36:39], s64 offen lds
    s_add_u32 s63, s59, 3
    s_and_b32 s63, s63, 3
    s_lshl_b32 s67, s63, 17
    s_add_u32 s67, s67, s69
    s_lshl_b32 s65, s63, 8
    s_add_u32 m0, s68, 114688
    s_nop 0
    buffer_load_dwordx4 v8, s[44:47], s67 offen offset:0 lds
    buffer_load_dwordx4 v9, s[44:47], s67 offen offset:1024 lds
    buffer_load_dwordx4 v10, s[44:47], s67 offen offset:2048 lds
    buffer_load_dwordx4 v11, s[44:47], s67 offen offset:3072 lds
    s_add_u32 m0, s52, 49152
    s_add_u32 s64, s48, s65
    buffer_load_dwordx4 v13, s[36:39], s64 offen lds
    s_add_u32 m0, s53, 49152
    s_add_u32 s64, s49, s65
    buffer_load_dwordx4 v13, s[36:39], s64 offen lds
    s_add_u32 m0, s54, 49152
    s_add_u32 s64, s50, s65
    buffer_load_dwordx4 v13, s[36:39], s64 offen lds
    s_branch h_rest
e_att:
    s_cmp_eq_u32 s3, 4
    s_cbranch_scc1 a_job
    s_and_b32 s68, s61, 1
    s_lshl_b32 s63, s68, 4
    s_or_b32 s63, s63, s3
    s_cmp_eq_u32 s63, 5
    s_cbranch_scc1 a_gate
    s_barrier
    s_waitcnt vmcnt(0) lgkmcnt(0)
    s_mov_b32 s17, 0
    s_mov_b32 s32, s34
    s_mov_b32 s33, s35
    s_mov_b32 s34, 7340032
    s_mov_b32 s35, 0x20000
    s_branch a_late
a_job:
    s_setprio 3
    s_and_b32 s68, s61, 1
    v_lshrrev_b32 v8, 4, v1
    v_lshlrev_b32 v8, 4, v8
    s_lshr_b32 s64, s76, 1
    s_lshl_b32 s65, s60, 1
    s_add_u32 s64, s64, s65
    s_mul_i32 s64, s64, 2080
    s_and_b32 s65, s76, 1
    v_and_b32 v17, 15, v1
    v_lshrrev_b32 v18, 4, v1
    v_xor_b32 v19, v17, v18
    v_lshlrev_b32 v19, 4, v19
    v_lshl_add_u32 v19, v17, 8, v19
    s_lshl_b32 s63, s76, 12
    v_add_u32 v20, s63, v19
    v_xor_b32 v21, 64, v20
    v_xor_b32 v22, 128, v20
    v_xor_b32 v23, 192, v20
    v_bfe_u32 v19, v1, 2, 2
    v_lshl_add_u32 v19, v18, 3, v19
    v_lshlrev_b32 v19, 5, v19
    v_and_b32 v24, 3, v1
    v_lshl_add_u32 v24, v24, 3, v19
    v_add_u32 v24, 131072, v24
    v_lshlrev_b32 v17, 4, v17
    v_lshrrev_b32 v18, 5, v1
    v_lshl_add_u32 v17, v18, 3, v17
    v_bfe_u32 v18, v1, 4, 1
    v_mov_b32 v9, 0
    v_mov_b32 v26, 149760
    s_mov_b32 s67, 196608
    s_lshr_b32 s69, s2, 2
    s_lshl_b32 s69, s69, 6
    s_and_b32 s63, s2, 3
    s_lshl_b32 s63, s63, 2
    s_add_u32 s69, s69, s63
    s_add_u32 s69, s69, 163840
    s_waitcnt lgkmcnt(0)
    s_mov_b32 s32, s34
    s_mov_b32 s33, s35
    s_mov_b32 s34, 7340032
    s_mov_b32 s35, 0x20000
    buffer_load_dword v10, v9, s[32:35], s67 offen sc1
    s_cmp_lg_u32 s68, 0
    s_cbranch_scc1 a_vjob
    s_lshl_b32 s65, s65, 8
    s_add_u32 s64, s64, s65
    v_lshl_add_u32 v17, v18, 9, v17
    s_lshl_b32 s65, s60, 2
    s_add_u32 s65, s65, s76
    s_lshl_b32 s65, s65, 2
    s_add_u32 s65, s65, 147456
    s_mov_b32 s17, 1
    s_branch a_kbody0
a_kbody0:
    s_barrier
a_kbody:
    ds_read_b128 v[32:35], v20 offset:0
    ds_read_b64_tr_b16 v[48:49], v24 offset:0
    ds_read_b64_tr_b16 v[50:51], v24 offset:128
    ds_read_b128 v[36:39], v21 offset:0
    ds_read_b64_tr_b16 v[52:53], v24 offset:1024
    ds_read_b64_tr_b16 v[54:55], v24 offset:1152
    ds_read_b128 v[40:43], v22 offset:0
    ds_read_b64_tr_b16 v[56:57], v24 offset:2048
    ds_read_b64_tr_b16 v[58:59], v24 offset:2176
    ds_read_b128 v[44:47], v23 offset:0
    ds_read_b64_tr_b16 v[60:61], v24 offset:3072
    ds_read_b64_tr_b16 v[62:63], v24 offset:3200
    s_waitcnt lgkmcnt(9)
    v_mfma_f32_16x16x32_bf16 v[28:31], v[48:51], v[32:35], 0
    ds_read_b128 v[32:35], v20 offset:16384
    ds_read_b64_tr_b16 v[48:49], v24 offset:4096
    ds_read_b64_tr_b16 v[50:51], v24 offset:4224
    s_waitcnt lgkmcnt(9)
    v_mfma_f32_16x16x32_bf16 v[28:31], v[52:55], v[36:39], v[28:31]
    ds_read_b128 v[36:39], v21 offset:16384
    ds_read_b64_tr_b16 v[52:53], v24 offset:5120
    ds_read_b64_tr_b16 v[54:55], v24 offset:5248
    s_waitcnt lgkmcnt(9)
    v_mfma_f32_16x16x32_bf16 v[28:31], v[56:59], v[40:43], v[28:31]
    ds_read_b128 v[40:43], v22 offset:16384
    ds_read_b64_tr_b16 v[56:57], v24 offset:6144
    ds_read_b64_tr_b16 v[58:59], v24 offset:6272
    s_waitcnt lgkmcnt(9)
    v_mfma_f32_16x16x32_bf16 v[28:31], v[60:63], v[44:47], v[28:31]
    ds_read_b128 v[44:47], v23 offset:16384
    ds_read_b64_tr_b16 v[60:61], v24 offset:7168
    ds_read_b64_tr_b16 v[62:63], v24 offset:7296
    s_waitcnt lgkmcnt(9)
    v_mfma_f32_16x16x32_bf16 v[28:31], v[48:51], v[32:35], v[28:31]
    ds_read_b128 v[32:35], v20 offset:32768
    ds_read_b64_tr_b16 v[48:49], v24 offset:8192
    ds_read_b64_tr_b16 v[50:51], v24 offset:8320
    s_waitcnt lgkmcnt(9)
    v_mfma_f32_16x16x32_bf16 v[28:31], v[52:55], v[36:39], v[28:31]
    ds_read_b128 v[36:39], v21 offset:32768
    ds_read_b64_tr_b16 v[52:53], v24 offset:9216
    ds_read_b64_tr_b16 v[54:55], v24 offset:9344
    s_waitcnt lgkmcnt(9)
    v_mfma_f32_16x16x32_bf16 v[28:31], v[56:59], v[40:43], v[28:31]
    ds_read_b128 v[40:43], v22 offset:32768
    ds_read_b64_tr_b16 v[56:57], v24 offset:10240
    ds_read_b64_tr_b16 v[58:59], v24 offset:10368
    s_waitcnt lgkmcnt(9)
    v_mfma_f32_16x16x32_bf16 v[28:31], v[60:63], v[44:47], v[28:31]
    ds_read_b128 v[44:47], v23 offset:32768
    ds_read_b64_tr_b16 v[60:61], v24 offset:11264
    ds_read_b64_tr_b16 v[62:63], v24 offset:11392
    s_waitcnt lgkmcnt(9)
    v_mfma_f32_16x16x32_bf16 v[28:31], v[48:51], v[32:35], v[28:31]
    ds_read_b128 v[32:35], v20 offset:49152
    ds_read_b64_tr_b16 v[48:49], v24 offset:12288
    ds_read_b64_tr_b16 v[50:51], v24 offset:12416
    s_waitcnt lgkmcnt(9)
    v_mfma_f32_16x16x32_bf16 v[28:31], v[52:55], v[36:39], v[28:31]
    ds_read_b128 v[36:39], v21 offset:49152
    ds_read_b64_tr_b16 v[52:53], v24 offset:13312
    ds_read_b64_tr_b16 v[54:55], v24 offset:13440
    s_waitcnt lgkmcnt(9)
    v_mfma_f32_16x16x32_bf16 v[28:31], v[56:59], v[40:43], v[28:31]
    ds_read_b128 v[40:43], v22 offset:49152
    ds_read_b64_tr_b16 v[56:57], v24 offset:14336
    ds_read_b64_tr_b16 v[58:59], v24 offset:14464
    s_waitcnt lgkmcnt(9)
    v_mfma_f32_16x16x32_bf16 v[28:31], v[60:63], v[44:47], v[28:31]
    ds_read_b128 v[44:47], v23 offset:49152
    ds_read_b64_tr_b16 v[60:61], v24 offset:15360
    ds_read_b64_tr_b16 v[62:63], v24 offset:15488
    s_waitcnt lgkmcnt(9)
    v_mfma_f32_16x16x32_bf16 v[28:31], v[48:51], v[32:35], v[28:31]
    s_waitcnt lgkmcnt(6)
    v_mfma_f32_16x16x32_bf16 v[28:31], v[52:55], v[36:39], v[28:31]
    s_waitcnt lgkmcnt(3)
    v_mfma_f32_16x16x32_bf16 v[28:31], v[56:59], v[40:43], v[28:31]
    s_waitcnt lgkmcnt(0)
    v_mfma_f32_16x16x32_bf16 v[28:31], v[60:63], v[44:47], v[28:31]
    s_xor_b32 s17, s17, 1
    s_cbranch_scc1 a_kbody0
    s_mov_b32 s63, 0x3eb8aa3b
    s_nop 4
    v_mul_f32 v28, s63, v28
    v_mul_f32 v29, s63, v29
    v_mul_f32 v30, s63, v30
    v_mul_f32 v31, s63, v31
    v_cvt_pk_bf16_f32 v36, v28, v29
    v_cvt_pk_bf16_f32 v37, v30, v31
    buffer_store_dwordx2 v[36:37], v17, s[32:35], s64 offen sc1
    v_mul_f32 v38, v28, v28
    v_fmac_f32 v38, v29, v29
    v_fmac_f32 v38, v30, v30
    v_fmac_f32 v38, v31, v31
    v_mov_b32 v39, v38
    s_nop 1
    v_permlane32_swap_b32 v38, v39
    v_add_f32 v38, v38, v39
    v_mov_b32 v39, v38
    s_nop 1
    v_permlane16_swap_b32 v38, v39
    v_add_f32 v38, v38, v39
    s_nop 1
    v_max_f32_dpp v38, v38, v38 row_ror:8 row_mask:0xf bank_mask:0xf
    s_nop 1
    v_max_f32_dpp v38, v38, v38 row_ror:4 row_mask:0xf bank_mask:0xf
    s_nop 1
    v_max_f32_dpp v38, v38, v38 row_ror:2 row_mask:0xf bank_mask:0xf
    s_nop 1
    v_max_f32_dpp v38, v38, v38 row_ror:1 row_mask:0xf bank_mask:0xf
    s_mov_b64 exec, 1
    buffer_store_dword v38, v9, s[32:35], s65 offen sc1
    s_branch a_jobdone
a_vjob:
    s_mul_i32 s65, s65, 528
    s_add_u32 s64, s64, s65
    v_mov_b32 v12, 0x3f803f80
    v_mov_b32 v13, 0x3f803f80
    v_mov_b32 v14, 0x3f803f80
    v_mov_b32 v15, 0x3f803f80
    s_mov_b64 exec, 1
    buffer_store_dwordx4 v[12:15], v9, s[32:35], s64 offen offset:1536 sc1
    s_mov_b64 exec, -1
    v_lshl_add_u32 v17, v18, 8, v17
    s_mov_b32 s17, 1
    s_branch a_vbody0
a_vbody0:
    s_barrier
a_vbody:
    ds_read_b128 v[32:35], v20 offset:0
    ds_read_b64_tr_b16 v[48:49], v24 offset:0
    ds_read_b64_tr_b16 v[50:51], v24 offset:128
    ds_read_b128 v[36:39], v21 offset:0
    ds_read_b64_tr_b16 v[52:53], v24 offset:1024
    ds_read_b64_tr_b16 v[54:55], v24 offset:1152
    ds_read_b128 v[40:43], v22 offset:0
    ds_read_b64_tr_b16 v[56:57], v24 offset:2048
    ds_read_b64_tr_b16 v[58:59], v24 offset:2176
    ds_read_b128 v[44:47], v23 offset:0
    ds_read_b64_tr_b16 v[60:61], v24 offset:3072
    ds_read_b64_tr_b16 v[62:63], v24 offset:3200
    s_waitcnt lgkmcnt(9)
    v_mfma_f32_16x16x32_bf16 v[28:31], v[32:35], v[48:51], 0
    ds_read_b128 v[32:35], v20 offset:16384
    ds_read_b64_tr_b16 v[48:49], v24 offset:4096
    ds_read_b64_tr_b16 v[50:51], v24 offset:4224
    s_waitcnt lgkmcnt(9)
    v_mfma_f32_16x16x32_bf16 v[28:31], v[36:39], v[52:55], v[28:31]
    ds_read_b128 v[36:39], v21 offset:16384
    ds_read_b64_tr_b16 v[52:53], v24 offset:5120
    ds_read_b64_tr_b16 v[54:55], v24 offset:5248
    s_waitcnt lgkmcnt(9)
    v_mfma_f32_16x16x32_bf16 v[28:31], v[40:43], v[56:59], v[28:31]
    ds_read_b128 v[40:43], v22 offset:16384
    ds_read_b64_tr_b16 v[56:57], v24 offset:6144
    ds_read_b64_tr_b16 v[58:59], v24 offset:6272
    s_waitcnt lgkmcnt(9)
    v_mfma_f32_16x16x32_bf16 v[28:31], v[44:47], v[60:63], v[28:31]
    ds_read_b128 v[44:47], v23 offset:16384
    ds_read_b64_tr_b16 v[60:61], v24 offset:7168
    ds_read_b64_tr_b16 v[62:63], v24 offset:7296
    s_waitcnt lgkmcnt(9)
    v_mfma_f32_16x16x32_bf16 v[28:31], v[32:35], v[48:51], v[28:31]
    ds_read_b128 v[32:35], v20 offset:32768
    ds_read_b64_tr_b16 v[48:49], v24 offset:8192
    ds_read_b64_tr_b16 v[50:51], v24 offset:8320
    s_waitcnt lgkmcnt(9)
    v_mfma_f32_16x16x32_bf16 v[28:31], v[36:39], v[52:55], v[28:31]
    ds_read_b128 v[36:39], v21 offset:32768
    ds_read_b64_tr_b16 v[52:53], v24 offset:9216
    ds_read_b64_tr_b16 v[54:55], v24 offset:9344
    s_waitcnt lgkmcnt(9)
    v_mfma_f32_16x16x32_bf16 v[28:31], v[40:43], v[56:59], v[28:31]
    ds_read_b128 v[40:43], v22 offset:32768
    ds_read_b64_tr_b16 v[56:57], v24 offset:10240
    ds_read_b64_tr_b16 v[58:59], v24 offset:10368
    s_waitcnt lgkmcnt(9)
    v_mfma_f32_16x16x32_bf16 v[28:31], v[44:47], v[60:63], v[28:31]
    ds_read_b128 v[44:47], v23 offset:32768
    ds_read_b64_tr_b16 v[60:61], v24 offset:11264
    ds_read_b64_tr_b16 v[62:63], v24 offset:11392
    s_waitcnt lgkmcnt(9)
    v_mfma_f32_16x16x32_bf16 v[28:31], v[32:35], v[48:51], v[28:31]
    ds_read_b128 v[32:35], v20 offset:49152
    ds_read_b64_tr_b16 v[48:49], v24 offset:12288
    ds_read_b64_tr_b16 v[50:51], v24 offset:12416
    s_waitcnt lgkmcnt(9)
    v_mfma_f32_16x16x32_bf16 v[28:31], v[36:39], v[52:55], v[28:31]
    ds_read_b128 v[36:39], v21 offset:49152
    ds_read_b64_tr_b16 v[52:53], v24 offset:13312
    ds_read_b64_tr_b16 v[54:55], v24 offset:13440
    s_waitcnt lgkmcnt(9)
    v_mfma_f32_16x16x32_bf16 v[28:31], v[40:43], v[56:59], v[28:31]
    ds_read_b128 v[40:43], v22 offset:49152
    ds_read_b64_tr_b16 v[56:57], v24 offset:14336
    ds_read_b64_tr_b16 v[58:59], v24 offset:14464
    s_waitcnt lgkmcnt(9)
    v_mfma_f32_16x16x32_bf16 v[28:31], v[44:47], v[60:63], v[28:31]
    ds_read_b128 v[44:47], v23 offset:49152
    ds_read_b64_tr_b16 v[60:61], v24 offset:15360
    ds_read_b64_tr_b16 v[62:63], v24 offset:15488
    s_waitcnt lgkmcnt(9)
    v_mfma_f32_16x16x32_bf16 v[28:31], v[32:35], v[48:51], v[28:31]
    s_waitcnt lgkmcnt(6)
    v_mfma_f32_16x16x32_bf16 v[28:31], v[36:39], v[52:55], v[28:31]
    s_waitcnt lgkmcnt(3)
    v_mfma_f32_16x16x32_bf16 v[28:31], v[40:43], v[56:59], v[28:31]
    s_waitcnt lgkmcnt(0)
    v_mfma_f32_16x16x32_bf16 v[28:31], v[44:47], v[60:63], v[28:31]
    s_xor_b32 s17, s17, 1
    s_cbranch_scc1 a_vbody0
    s_nop 5
    v_cvt_pk_bf16_f32 v36, v28, v29
    v_cvt_pk_bf16_f32 v37, v30, v31
    buffer_store_dwordx2 v[36:37], v17, s[32:35], s64 offen offset:1024 sc1
    s_mov_b64 exec, 1
a_jobdone:
    s_mov_b32 s63, 0x9e3779b1
    s_waitcnt vmcnt(1)
    v_mul_lo_u32 v10, v10, s63
    v_add_u32 v10, 0x7f4a7c15, v10
    s_waitcnt vmcnt(0)
    buffer_store_dword v10, v9, s[32:35], s69 offen sc1
    ds_write_b32 v26, v10 offset:56
    s_mov_b64 exec, -1
    s_setprio 0
    s_branch a_late2
h_rest:
    s_mov_b32 s32, s34
    s_mov_b32 s33, s35
    s_mov_b32 s34, 7340032
    s_mov_b32 s35, 0x20000
    s_waitcnt vmcnt(14)
    s_barrier
    s_lshr_b32 s16, s66, 1
    s_and_b32 s17, s66, 1
    s_lshl_b32 s62, s60, 1
    s_add_u32 s62, s62, s57
    s_add_u32 s62, s62, s16
    v_lshrrev_b32 v5, 3, v1
    v_and_b32 v6, 7, v1
    v_lshlrev_b32 v6, 4, v6
    v_lshl_add_u32 v6, v5, 10, v6
    s_lshl_b32 s63, s57, 1
    v_add_u32 v6, s63, v6
    s_lshl_b32 s63, s66, 4
    s_add_u32 s63, s63, s57
    v_and_b32 v7, 15, v1
    v_add_u32 v7, s63, v7
    v_lshlrev_b32 v18, 3, v7
    s_lshl_b32 s64, s56, 10
    s_sub_u32 s64, s64, 3072
    v_lshrrev_b32 v17, 4, v1
    v_lshlrev_b32 v19, 14, v17
    v_lshl_add_u32 v19, v7, 1, v19
    v_add_u32 v19, s64, v19
    s_lshl_b32 s63, s62, 1
    v_mov_b32 v20, s63
    v_bfe_u32 v16, v1, 2, 2
    v_lshlrev_b32 v16, 7, v16
    v_lshl_add_u32 v16, v17, 12, v16
    v_lshlrev_b32 v24, 5, v17
    v_and_b32 v17, 3, v1
    v_lshl_add_u32 v16, v17, 3, v16
    s_lshl_b32 s63, s66, 5
    s_add_u32 s63, s63, 133120
    v_add_u32 v16, s63, v16
    v_lshrrev_b32 v26, 2, v1
    v_mul_u32_u24 v32, 4160, v26
    v_mul_u32_u24 v26, 144, v26
    v_lshlrev_b32 v17, 4, v17
    v_sub_u32 v26, v17, v26
    s_lshl_b32 s63, s16, 6
    s_add_u32 s63, s63, 156784
    v_add_u32 v26, s63, v26
    v_and_b32 v21, 0x1f7, v7
    v_lshlrev_b32 v21, 12, v21
    v_sub_u32 v21, v21, v24
    v_and_b32 v9, 8, v1
    v_lshl_add_u32 v21, v9, 1, v21
    v_add_u32 v21, 96, v21
    s_mul_i32 s71, s16, 8320
    s_add_u32 s71, s71, 133120
    v_add_u32 v27, s71, v2
    v_add_u32 v32, v32, v17
    s_add_u32 s63, s71, 4096
    v_add_u32 v32, s63, v32
    v_and_b32 v4, 31, v1
    v_lshrrev_b32 v5, 5, v1
    v_or_b32 v9, 1, v4
    v_lshlrev_b32 v17, 3, v5
    v_sub_u32 v9, v17, v9
    s_cmp_eq_u32 s17, 0
    s_cselect_b32 s63, 1055, 31
    s_sub_u32 s63, s63, 256
    v_add_u32 v9, s63, v9
    v_lshlrev_b32 v9, 1, v9
    v_and_b32 v17, 1, v4
    v_xor_b32 v17, 1, v17
    v_mul_u32_u24 v17, 4160, v17
    v_add3_u32 v34, v9, v17, s71
    v_mul_u32_u24 v9, 144, v4
    v_lshlrev_b32 v17, 4, v5
    v_sub_u32 v9, v17, v9
    s_lshl_b32 s63, s16, 6
    s_add_u32 s63, s63, 168304
    v_add_u32 v35, s63, v9
    v_mov_b32 v28, 0
    v_mov_b32 v29, 0
    v_mov_b32 v30, 0
    v_mov_b32 v31, 0
    s_lshl_b32 s63, s17, 11
    v_lshlrev_b32 v22, 6, v4
    v_lshl_add_u32 v22, v5, 3, v22
    v_add_u32 v22, s63, v22
    s_add_u32 s63, s71, 4040
    v_sub_u32 v22, s63, v22
    v_and_b32 v23, 27, v4
    v_lshlrev_b32 v23, 6, v23
    v_lshl_add_u32 v23, v5, 4, v23
    v_and_b32 v9, 4, v4
    v_lshl_add_u32 v23, v9, 3, v23
    s_lshl_b32 s63, s17, 11
    v_add_u32 v23, s63, v23
    v_mov_b32 v128, 0
    v_mov_b32 v129, 0
    v_mov_b32 v130, 0
    v_mov_b32 v131, 0
    v_mov_b32 v132, 0
    v_mov_b32 v133, 0
    v_mov_b32 v134, 0
    v_mov_b32 v135, 0
    v_mov_b32 v136, 0
    v_mov_b32 v137, 0
    v_mov_b32 v138, 0
    v_mov_b32 v139, 0
    v_mov_b32 v140, 0
    v_mov_b32 v141, 0
    v_mov_b32 v142, 0
    v_mov_b32 v143, 0
    v_mov_b32 v93, 0xffff
    ds_read_b32 v36, v3 offset:56
    s_waitcnt vmcnt(0) lgkmcnt(0)
    v_readfirstlane_b32 s77, v36
    s_barrier
    s_setprio 3
    s_lshr_b32 s67, s66, 1
    s_and_b32 s68, s66, 1
    s_lshl_b32 s69, s60, 1
    s_add_u32 s69, s69, s57
    s_add_u32 s69, s69, s67
    s_lshl_b32 s70, s69, 12
    s_mov_b32 s36, s6
    s_mov_b32 s37, s7
    s_mov_b32 s38, 2097152
    s_mov_b32 s39, 0x20000
    s_mov_b32 s40, s8
    s_mov_b32 s41, s9
    s_mov_b32 s42, 2097152
    s_mov_b32 s43, 0x20000
    s_mov_b32 s44, s10
    s_mov_b32 s45, s11
    s_mov_b32 s46, 4096
    s_mov_b32 s47, 0x20000
    s_add_u32 s48, s12, s70
    s_addc_u32 s49, s13, 0
    s_mov_b32 s50, 4096
    s_mov_b32 s51, 0x20000
    s_mov_b32 s52, s14
    s_mov_b32 s53, s15
    s_mov_b32 s54, 1024
    s_mov_b32 s55, 0x20000
    s_lshl_b32 s63, s67, 2
    s_add_u32 s63, s63, s58
    s_and_b32 s63, s63, 7
    s_mul_i32 s59, s63, 65
    s_lshr_b32 s59, s59, 2
    s_add_u32 s59, s59, s68
    s_add_u32 s59, s59, 12
    s_lshl_b32 s64, s66, 4
    s_add_u32 s64, s64, s56
    s_lshl_b32 s64, s64, 10
    s_add_u32 s65, s64, 8192
    s_lshl_b32 s73, s66, 12
    s_add_u32 s73, s73, 133120
    s_mov_b32 s72, 163840
    v_lshlrev_b32 v36, 6, v1
    s_cmp_lg_u32 s66, 0
    s_cbranch_scc1 h_nopoll
    s_barrier
    buffer_load_dwordx4 v[40:43], v36, s[32:35], s72 offen sc1
    s_mov_b32 s75, 0x40000
h_pollkv:
    s_sub_u32 s75, s75, 1
    s_waitcnt vmcnt(0)
    v_xor_b32 v40, s77, v40
    v_xor_b32 v41, s77, v41
    v_xor_b32 v42, s77, v42
    v_xor_b32 v43, s77, v43
    v_or3_b32 v40, v40, v41, v42
    v_or_b32 v40, v40, v43
    v_cmp_ne_u32 vcc, 0, v40
    s_cbranch_vccz h_kvready
    s_mov_b64 exec, vcc
    buffer_load_dwordx4 v[40:43], v36, s[32:35], s72 offen sc1
    s_cmp_lg_u32 s75, 0
    s_cbranch_scc1 h_pollkv
h_kvready:
    s_waitcnt vmcnt(0)
    s_mov_b64 exec, -1
    ds_write_b32 v3, v14
    s_branch h_b1
h_nopoll:
    s_barrier
h_b1:
    s_barrier
    s_mov_b32 s72, 5
h_bulk1:
    s_cmp_ge_u32 s59, 130
    s_cselect_b32 s63, 130, 0
    s_sub_u32 s59, s59, s63
    s_lshl_b32 s63, s59, 10
    s_add_u32 s59, s59, 2
    s_mov_b32 m0, s63
    s_nop 0
    buffer_load_dwordx4 v2, s[32:35], s63 offen sc1 lds
    s_sub_u32 s72, s72, 1
    s_cmp_lg_u32 s72, 0
    s_cbranch_scc1 h_bulk1
    s_waitcnt vmcnt(0)
    s_mov_b64 exec, 1
    ds_add_u32 v3, v14 offset:4
    s_mov_b64 exec, -1
    s_mov_b32 m0, s73
    s_nop 0
    buffer_load_dwordx4 v6, s[36:39], s64 offen  lds
    s_add_u32 s63, s73, 1024
    s_mov_b32 m0, s63
    s_nop 0
    buffer_load_dwordx4 v6, s[36:39], s65 offen  lds
    s_add_u32 s63, s73, 2048
    s_mov_b32 m0, s63
    s_nop 0
    buffer_load_dwordx4 v6, s[40:43], s64 offen  lds
    s_add_u32 s63, s73, 3072
    s_mov_b32 m0, s63
    s_nop 0
    buffer_load_dwordx4 v6, s[40:43], s65 offen  lds
    buffer_load_dwordx2 v[10:11], v18, s[44:47], 0 offen
    buffer_load_ushort v12, v19, s[36:39], 0 offen
    buffer_load_ushort v13, v19, s[36:39], 0 offen offset:1024
    buffer_load_ushort v15, v19, s[36:39], 0 offen offset:2048
    s_mov_b32 s72, 13
h_bulk2:
    s_cmp_ge_u32 s59, 130
    s_cselect_b32 s63, 130, 0
    s_sub_u32 s59, s59, s63
    s_lshl_b32 s63, s59, 10
    s_add_u32 s59, s59, 2
    s_mov_b32 m0, s63
    s_nop 0
    buffer_load_dwordx4 v2, s[32:35], s63 offen sc1 lds
    s_sub_u32 s72, s72, 1
    s_cmp_lg_u32 s72, 0
    s_cbranch_scc1 h_bulk2
    s_waitcnt vmcnt(4)
    s_mov_b64 exec, 1
    ds_add_u32 v3, v14 offset:8
    s_mov_b64 exec, -1
    s_mov_b64 exec, 1
    ds_add_u32 v3, v14 offset:40
    s_mov_b64 exec, -1
    s_mov_b32 s75, 0x100000
lw1:
    ds_read_b32 v9, v3 offset:40
    s_sub_u32 s75, s75, 1
    s_waitcnt lgkmcnt(0)
    v_readfirstlane_b32 s74, v9
    s_nop 0
    s_cmp_ge_u32 s74, 4
    s_cbranch_scc1 lw1_ok
    s_sleep 1
    s_cmp_lg_u32 s75, 0
    s_cbranch_scc1 lw1
lw1_ok:
    ds_read_b64_tr_b16 v[96:97], v16 offset:0
    ds_read_b64_tr_b16 v[98:99], v16 offset:512
    ds_read_b64_tr_b16 v[100:101], v16 offset:1024
    ds_read_b64_tr_b16 v[102:103], v16 offset:1536
    ds_read_b64_tr_b16 v[104:105], v16 offset:2048
    ds_read_b64_tr_b16 v[106:107], v16 offset:2560
    ds_read_b64_tr_b16 v[108:109], v16 offset:3072
    ds_read_b64_tr_b16 v[110:111], v16 offset:3584
    v_alignbit_b32 v88, v11, v11, 16
    v_alignbit_b32 v89, v10, v10, 16
    v_and_b32 v90, 0xffff0000, v11
    v_bfi_b32 v91, v93, v11, v10
    v_and_b32 v92, 0xffff, v10
    v_lshlrev_b32 v94, 16, v12
    v_lshl_or_b32 v95, v15, 16, v13
    s_waitcnt lgkmcnt(0)
    v_dot2_f32_bf16 v52, v94, v90, 0
    v_dot2_f32_bf16 v53, v95, v88, 0
    v_dot2_f32_bf16 v54, v95, v90, 0
    v_dot2_f32_bf16 v55, v96, v88, 0
    v_dot2_f32_bf16 v56, v96, v90, 0
    v_dot2_f32_bf16 v57, v97, v88, 0
    v_dot2_f32_bf16 v58, v97, v90, 0
    v_dot2_f32_bf16 v59, v98, v88, 0
    v_dot2_f32_bf16 v60, v98, v90, 0
    v_dot2_f32_bf16 v61, v99, v88, 0
    v_dot2_f32_bf16 v62, v99, v90, 0
    v_dot2_f32_bf16 v63, v100, v88, 0
    v_dot2_f32_bf16 v64, v100, v90, 0
    v_dot2_f32_bf16 v65, v101, v88, 0
    v_dot2_f32_bf16 v66, v101, v90, 0
    v_dot2_f32_bf16 v67, v102, v88, 0
    v_dot2_f32_bf16 v52, v95, v91, v52
    v_dot2_f32_bf16 v53, v96, v89, v53
    v_dot2_f32_bf16 v54, v96, v91, v54
    v_dot2_f32_bf16 v55, v97, v89, v55
    v_dot2_f32_bf16 v56, v97, v91, v56
    v_dot2_f32_bf16 v57, v98, v89, v57
    v_dot2_f32_bf16 v58, v98, v91, v58
    v_dot2_f32_bf16 v59, v99, v89, v59
    v_dot2_f32_bf16 v60, v99, v91, v60
    v_dot2_f32_bf16 v61, v100, v89, v61
    v_dot2_f32_bf16 v62, v100, v91, v62
    v_dot2_f32_bf16 v63, v101, v89, v63
    v_dot2_f32_bf16 v64, v101, v91, v64
    v_dot2_f32_bf16 v65, v102, v89, v65
    v_dot2_f32_bf16 v66, v102, v91, v66
    v_dot2_f32_bf16 v67, v103, v89, v67
    v_dot2_f32_bf16 v52, v96, v92, v52
    v_lshlrev_b32 v72, 16, v104
    v_and_b32 v73, 0xffff0000, v104
    v_dot2_f32_bf16 v54, v97, v92, v54
    v_lshlrev_b32 v74, 16, v105
    v_and_b32 v75, 0xffff0000, v105
    v_dot2_f32_bf16 v56, v98, v92, v56
    v_lshlrev_b32 v76, 16, v106
    v_and_b32 v77, 0xffff0000, v106
    v_dot2_f32_bf16 v58, v99, v92, v58
    v_lshlrev_b32 v78, 16, v107
    v_and_b32 v79, 0xffff0000, v107
    v_dot2_f32_bf16 v60, v100, v92, v60
    v_lshlrev_b32 v80, 16, v108
    v_and_b32 v81, 0xffff0000, v108
    v_dot2_f32_bf16 v62, v101, v92, v62
    v_lshlrev_b32 v82, 16, v109
    v_and_b32 v83, 0xffff0000, v109
    v_dot2_f32_bf16 v64, v102, v92, v64
    v_lshlrev_b32 v84, 16, v110
    v_and_b32 v85, 0xffff0000, v110
    v_dot2_f32_bf16 v66, v103, v92, v66
    v_lshlrev_b32 v86, 16, v111
    v_and_b32 v87, 0xffff0000, v111
    v_pk_mul_f32 v[72:73], v[72:73], v[52:53]
    v_pk_mul_f32 v[74:75], v[74:75], v[54:55]
    v_pk_mul_f32 v[76:77], v[76:77], v[56:57]
    v_pk_mul_f32 v[78:79], v[78:79], v[58:59]
    v_pk_mul_f32 v[80:81], v[80:81], v[60:61]
    v_pk_mul_f32 v[82:83], v[82:83], v[62:63]
    v_pk_mul_f32 v[84:85], v[84:85], v[64:65]
    v_pk_mul_f32 v[86:87], v[86:87], v[66:67]
    v_cvt_pk_bf16_f32 v44, v87, v86
    v_cvt_pk_bf16_f32 v45, v85, v84
    v_cvt_pk_bf16_f32 v46, v83, v82
    v_cvt_pk_bf16_f32 v47, v81, v80
    v_cvt_pk_bf16_f32 v48, v79, v78
    v_cvt_pk_bf16_f32 v49, v77, v76
    v_cvt_pk_bf16_f32 v50, v75, v74
    v_cvt_pk_bf16_f32 v51, v73, v72
    v_mov_b32 v52, v44
    v_mov_b32 v53, v45
    v_mov_b32 v54, v46
    v_mov_b32 v55, v47
    v_mov_b32_dpp v44, v48 row_ror:8 row_mask:0xf bank_mask:0xc
    v_mov_b32_dpp v48, v52 row_ror:8 row_mask:0xf bank_mask:0x3
    v_mov_b32_dpp v45, v49 row_ror:8 row_mask:0xf bank_mask:0xc
    v_mov_b32_dpp v49, v53 row_ror:8 row_mask:0xf bank_mask:0x3
    v_mov_b32_dpp v46, v50 row_ror:8 row_mask:0xf bank_mask:0xc
    v_mov_b32_dpp v50, v54 row_ror:8 row_mask:0xf bank_mask:0x3
    v_mov_b32_dpp v47, v51 row_ror:8 row_mask:0xf bank_mask:0xc
    v_mov_b32_dpp v51, v55 row_ror:8 row_mask:0xf bank_mask:0x3
    s_lshl_b32 s64, s56, 1
    s_sub_u32 s64, 1052544, s64
    s_add_u32 s63, s64, 32768
    buffer_store_dwordx4 v[44:47], v21, s[32:35], s64 offen sc1
    buffer_store_dwordx4 v[48:51], v21, s[32:35], s63 offen sc1
    s_lshl_b32 s72, s61, 11
    s_lshl_b32 s65, s60, 6
    s_add_u32 s65, s65, s72
    s_add_u32 s64, s72, 180224
    s_add_u32 s73, s65, 180224
    s_mov_b32 s72, 9
h_bulk3b:
    s_cmp_ge_u32 s59, 130
    s_cselect_b32 s63, 130, 0
    s_sub_u32 s59, s59, s63
    s_lshl_b32 s63, s59, 10
    s_add_u32 s59, s59, 2
    s_mov_b32 m0, s63
    s_nop 0
    buffer_load_dwordx4 v2, s[32:35], s63 offen sc1 lds
    s_sub_u32 s72, s72, 1
    s_cmp_lg_u32 s72, 0
    s_cbranch_scc1 h_bulk3b
    buffer_load_dwordx4 v[144:147], v2, s[48:51], 0 offen offset:0
    buffer_load_dwordx4 v[148:151], v2, s[48:51], 0 offen offset:1024
    buffer_load_dwordx4 v[152:155], v2, s[48:51], 0 offen offset:2048
    buffer_load_dwordx4 v[156:159], v2, s[48:51], 0 offen offset:3072
    buffer_load_ushort v25, v20, s[52:55], 0 offen
    s_waitcnt vmcnt(14)
    s_mov_b64 exec, 1
    ds_add_rtn_u32 v16, v3, v14 offset:16
    s_waitcnt lgkmcnt(0)
    v_readfirstlane_b32 s74, v16
    s_nop 0
    s_cmp_lg_u32 s74, 3
    s_cbranch_scc1 pb2
    v_mov_b32 v16, s77
    v_mov_b32 v18, 0
    buffer_store_dword v16, v18, s[32:35], s73 offen sc1
pb2:
    s_mov_b64 exec, -1
    s_waitcnt vmcnt(5)
    s_mov_b64 exec, 1
    ds_add_u32 v3, v14 offset:60
    s_mov_b64 exec, -1
    s_waitcnt vmcnt(0)
    ds_write_b128 v26, v[144:147] offset:6912
    ds_write_b128 v26, v[148:151] offset:4608
    ds_write_b128 v26, v[152:155] offset:2304
    ds_write_b128 v26, v[156:159] offset:0
    s_add_u32 s63, s70, 1048576
    s_add_u32 s40, s32, s63
    s_addc_u32 s41, s33, 0
    s_mov_b32 s42, 4096
    s_mov_b32 s43, 0x20000
    s_add_u32 s63, s70, 5242880
    s_add_u32 s44, s32, s63
    s_addc_u32 s45, s33, 0
    s_mov_b32 s46, 4096
    s_mov_b32 s47, 0x20000
    s_cmp_lg_u32 s66, 0
    s_cbranch_scc1 pl3_lds
    v_lshlrev_b32 v16, 6, v1
    s_mov_b32 exec_hi, 0
    s_mov_b32 s75, 0x40000
pl3:
    buffer_load_dword v17, v16, s[32:35], s64 offen sc1
    s_sub_u32 s75, s75, 1
    s_waitcnt vmcnt(0)
    v_cmp_ne_u32 vcc, s77, v17
    s_cbranch_vccz pl3_ok
    s_mov_b64 exec, vcc
    s_sleep 4
    s_cmp_lg_u32 s75, 0
    s_cbranch_scc1 pl3
pl3_ok:
    s_mov_b64 exec, -1
    ds_write_b32 v3, v14 offset:52
    s_branch pl3_done
pl3_lds:
    s_mov_b32 s75, 0x100000
lw4:
    ds_read_b32 v16, v3 offset:52
    s_sub_u32 s75, s75, 1
    s_waitcnt lgkmcnt(0)
    v_readfirstlane_b32 s74, v16
    s_nop 0
    s_cmp_ge_u32 s74, 1
    s_cbranch_scc1 lw4_ok
    s_sleep 2
    s_cmp_lg_u32 s75, 0
    s_cbranch_scc1 lw4
lw4_ok:
pl3_done:
    buffer_load_dwordx4 v[52:55], v2, s[40:43], 0 offen offset:0 sc1
    buffer_load_dword v56, v2, s[40:43], 0 offen offset:16 sc1
    buffer_load_dwordx4 v[58:61], v2, s[40:43], 0 offen offset:1024 sc1
    buffer_load_dword v62, v2, s[40:43], 0 offen offset:1040 sc1
    buffer_load_dwordx4 v[64:67], v2, s[40:43], 0 offen offset:2048 sc1
    buffer_load_dword v68, v2, s[40:43], 0 offen offset:2064 sc1
    buffer_load_dwordx4 v[70:73], v2, s[40:43], 0 offen offset:3072 sc1
    buffer_load_dword v74, v2, s[40:43], 0 offen offset:3088 sc1
    s_mov_b32 s36, s26
    s_mov_b32 s37, s27
    s_mov_b32 s38, 524288
    s_mov_b32 s39, 0x20000
    s_lshr_b32 s63, s2, 3
    s_lshl_b32 s63, s63, 14
    s_lshl_b32 s74, s66, 12
    s_add_u32 s63, s63, s74
    buffer_load_dwordx4 v[160:163], v2, s[36:39], s63 offen offset:0
    buffer_load_dwordx4 v[160:163], v2, s[36:39], s63 offen offset:1024
    buffer_load_dwordx4 v[160:163], v2, s[36:39], s63 offen offset:2048
    buffer_load_dwordx4 v[160:163], v2, s[36:39], s63 offen offset:3072
    s_mov_b64 exec, 0xff
    ds_write_b128 v32, v[28:31]
    s_mov_b64 exec, -1
    s_waitcnt vmcnt(10)
    ds_write_b128 v27, v[52:55] offset:0
    v_alignbit_b32 v36, v53, v52, 16
    v_alignbit_b32 v37, v54, v53, 16
    v_alignbit_b32 v38, v55, v54, 16
    v_alignbit_b32 v39, v56, v55, 16
    ds_write_b128 v27, v[36:39] offset:4160
    s_waitcnt vmcnt(8)
    ds_write_b128 v27, v[58:61] offset:1024
    v_alignbit_b32 v40, v59, v58, 16
    v_alignbit_b32 v41, v60, v59, 16
    v_alignbit_b32 v42, v61, v60, 16
    v_alignbit_b32 v43, v62, v61, 16
    ds_write_b128 v27, v[40:43] offset:5184
    s_waitcnt vmcnt(6)
    ds_write_b128 v27, v[64:67] offset:2048
    v_alignbit_b32 v36, v65, v64, 16
    v_alignbit_b32 v37, v66, v65, 16
    v_alignbit_b32 v38, v67, v66, 16
    v_alignbit_b32 v39, v68, v67, 16
    ds_write_b128 v27, v[36:39] offset:6208
    s_waitcnt vmcnt(4)
    ds_write_b128 v27, v[70:73] offset:3072
    v_alignbit_b32 v40, v71, v70, 16
    v_alignbit_b32 v41, v72, v71, 16
    v_alignbit_b32 v42, v73, v72, 16
    v_alignbit_b32 v43, v74, v73, 16
    ds_write_b128 v27, v[40:43] offset:7232
    s_waitcnt lgkmcnt(0)
    s_cmp_eq_u32 s68, 0
    s_cselect_b32 s72, 2, 6
    s_setprio 3
h_conv1:
    v_add_u32 v34, 512, v34
    v_subrev_u32 v35, 1152, v35
    ds_read2_b32 v[48:49], v34 offset0:0 offset1:1
    ds_read2_b32 v[50:51], v34 offset0:2 offset1:3
    ds_read2_b32 v[52:53], v34 offset0:8 offset1:9
    ds_read2_b32 v[54:55], v34 offset0:10 offset1:11
    ds_read_b128 v[80:83], v35 offset:1008
    ds_read_b128 v[84:87], v35 offset:1040
    s_waitcnt lgkmcnt(0)
    v_mfma_f32_32x32x16_bf16 v[128:143], v[48:51], v[80:83], v[128:143]
    v_mfma_f32_32x32x16_bf16 v[128:143], v[52:55], v[84:87], v[128:143]
    ds_read2_b32 v[56:57], v34 offset0:16 offset1:17
    ds_read2_b32 v[58:59], v34 offset0:18 offset1:19
    ds_read2_b32 v[60:61], v34 offset0:24 offset1:25
    ds_read2_b32 v[62:63], v34 offset0:26 offset1:27
    ds_read_b128 v[88:91], v35 offset:864
    ds_read_b128 v[92:95], v35 offset:896
    s_waitcnt lgkmcnt(0)
    v_mfma_f32_32x32x16_bf16 v[128:143], v[56:59], v[88:91], v[128:143]
    v_mfma_f32_32x32x16_bf16 v[128:143], v[60:63], v[92:95], v[128:143]
    ds_read2_b32 v[64:65], v34 offset0:32 offset1:33
    ds_read2_b32 v[66:67], v34 offset0:34 offset1:35
    ds_read2_b32 v[68:69], v34 offset0:40 offset1:41
    ds_read2_b32 v[70:71], v34 offset0:42 offset1:43
    ds_read_b128 v[96:99], v35 offset:720
    ds_read_b128 v[100:103], v35 offset:752
    s_waitcnt lgkmcnt(0)
    v_mfma_f32_32x32x16_bf16 v[128:143], v[64:67], v[96:99], v[128:143]
    v_mfma_f32_32x32x16_bf16 v[128:143], v[68:71], v[100:103], v[128:143]
    ds_read2_b32 v[72:73], v34 offset0:48 offset1:49
    ds_read2_b32 v[74:75], v34 offset0:50 offset1:51
    ds_read2_b32 v[76:77], v34 offset0:56 offset1:57
    ds_read2_b32 v[78:79], v34 offset0:58 offset1:59
    ds_read_b128 v[104:107], v35 offset:576
    ds_read_b128 v[108:111], v35 offset:608
    s_waitcnt lgkmcnt(0)
    v_mfma_f32_32x32x16_bf16 v[128:143], v[72:75], v[104:107], v[128:143]
    v_mfma_f32_32x32x16_bf16 v[128:143], v[76:79], v[108:111], v[128:143]
    ds_read2_b32 v[48:49], v34 offset0:64 offset1:65
    ds_read2_b32 v[50:51], v34 offset0:66 offset1:67
    ds_read2_b32 v[52:53], v34 offset0:72 offset1:73
    ds_read2_b32 v[54:55], v34 offset0:74 offset1:75
    ds_read_b128 v[80:83], v35 offset:432
    ds_read_b128 v[84:87], v35 offset:464
    s_waitcnt lgkmcnt(0)
    v_mfma_f32_32x32x16_bf16 v[128:143], v[48:51], v[80:83], v[128:143]
    v_mfma_f32_32x32x16_bf16 v[128:143], v[52:55], v[84:87], v[128:143]
    ds_read2_b32 v[56:57], v34 offset0:80 offset1:81
    ds_read2_b32 v[58:59], v34 offset0:82 offset1:83
    ds_read2_b32 v[60:61], v34 offset0:88 offset1:89
    ds_read2_b32 v[62:63], v34 offset0:90 offset1:91
    ds_read_b128 v[88:91], v35 offset:288
    ds_read_b128 v[92:95], v35 offset:320
    s_waitcnt lgkmcnt(0)
    v_mfma_f32_32x32x16_bf16 v[128:143], v[56:59], v[88:91], v[128:143]
    v_mfma_f32_32x32x16_bf16 v[128:143], v[60:63], v[92:95], v[128:143]
    ds_read2_b32 v[64:65], v34 offset0:96 offset1:97
    ds_read2_b32 v[66:67], v34 offset0:98 offset1:99
    ds_read2_b32 v[68:69], v34 offset0:104 offset1:105
    ds_read2_b32 v[70:71], v34 offset0:106 offset1:107
    ds_read_b128 v[96:99], v35 offset:144
    ds_read_b128 v[100:103], v35 offset:176
    s_waitcnt lgkmcnt(0)
    v_mfma_f32_32x32x16_bf16 v[128:143], v[64:67], v[96:99], v[128:143]
    v_mfma_f32_32x32x16_bf16 v[128:143], v[68:71], v[100:103], v[128:143]
    ds_read2_b32 v[72:73], v34 offset0:112 offset1:113
    ds_read2_b32 v[74:75], v34 offset0:114 offset1:115
    ds_read2_b32 v[76:77], v34 offset0:120 offset1:121
    ds_read2_b32 v[78:79], v34 offset0:122 offset1:123
    ds_read_b128 v[104:107], v35 offset:0
    ds_read_b128 v[108:111], v35 offset:32
    s_waitcnt lgkmcnt(0)
    v_mfma_f32_32x32x16_bf16 v[128:143], v[72:75], v[104:107], v[128:143]
    v_mfma_f32_32x32x16_bf16 v[128:143], v[76:79], v[108:111], v[128:143]
    s_sub_u32 s72, s72, 1
    s_cmp_lg_u32 s72, 0
    s_cbranch_scc1 h_conv1
    s_cmp_lg_u32 s68, 0
    s_cbranch_scc1 h_convb
    s_waitcnt lgkmcnt(0)
    v_subrev_u32 v33, 4608, v35
    s_mov_b32 s72, 2
    v_mov_b32 v144, 0
    v_mov_b32 v145, 0
    v_mov_b32 v146, 0
    v_mov_b32 v147, 0
    v_mov_b32 v148, 0
    v_mov_b32 v149, 0
    v_mov_b32 v150, 0
    v_mov_b32 v151, 0
    v_mov_b32 v152, 0
    v_mov_b32 v153, 0
    v_mov_b32 v154, 0
    v_mov_b32 v155, 0
    v_mov_b32 v156, 0
    v_mov_b32 v157, 0
    v_mov_b32 v158, 0
    v_mov_b32 v159, 0
h_conv2:
    v_add_u32 v34, 512, v34
    v_subrev_u32 v35, 1152, v35
    v_subrev_u32 v33, 1152, v33
    ds_read2_b32 v[48:49], v34 offset0:0 offset1:1
    ds_read2_b32 v[50:51], v34 offset0:2 offset1:3
    ds_read_b128 v[80:83], v35 offset:1008
    ds_read_b128 v[112:115], v33 offset:1008
    s_waitcnt lgkmcnt(0)
    v_mfma_f32_32x32x16_bf16 v[128:143], v[48:51], v[80:83], v[128:143]
    v_mfma_f32_32x32x16_bf16 v[144:159], v[48:51], v[112:115], v[144:159]
    ds_read2_b32 v[52:53], v34 offset0:8 offset1:9
    ds_read2_b32 v[54:55], v34 offset0:10 offset1:11
    ds_read_b128 v[84:87], v35 offset:1040
    ds_read_b128 v[116:119], v33 offset:1040
    s_waitcnt lgkmcnt(0)
    v_mfma_f32_32x32x16_bf16 v[128:143], v[52:55], v[84:87], v[128:143]
    v_mfma_f32_32x32x16_bf16 v[144:159], v[52:55], v[116:119], v[144:159]
    ds_read2_b32 v[56:57], v34 offset0:16 offset1:17
    ds_read2_b32 v[58:59], v34 offset0:18 offset1:19
    ds_read_b128 v[88:91], v35 offset:864
    ds_read_b128 v[120:123], v33 offset:864
    s_waitcnt lgkmcnt(0)
    v_mfma_f32_32x32x16_bf16 v[128:143], v[56:59], v[88:91], v[128:143]
    v_mfma_f32_32x32x16_bf16 v[144:159], v[56:59], v[120:123], v[144:159]
    ds_read2_b32 v[60:61], v34 offset0:24 offset1:25
    ds_read2_b32 v[62:63], v34 offset0:26 offset1:27
    ds_read_b128 v[92:95], v35 offset:896
    ds_read_b128 v[124:127], v33 offset:896
    s_waitcnt lgkmcnt(0)
    v_mfma_f32_32x32x16_bf16 v[128:143], v[60:63], v[92:95], v[128:143]
    v_mfma_f32_32x32x16_bf16 v[144:159], v[60:63], v[124:127], v[144:159]
    ds_read2_b32 v[64:65], v34 offset0:32 offset1:33
    ds_read2_b32 v[66:67], v34 offset0:34 offset1:35
    ds_read_b128 v[96:99], v35 offset:720
    ds_read_b128 v[112:115], v33 offset:720
    s_waitcnt lgkmcnt(0)
    v_mfma_f32_32x32x16_bf16 v[128:143], v[64:67], v[96:99], v[128:143]
    v_mfma_f32_32x32x16_bf16 v[144:159], v[64:67], v[112:115], v[144:159]
    ds_read2_b32 v[68:69], v34 offset0:40 offset1:41
    ds_read2_b32 v[70:71], v34 offset0:42 offset1:43
    ds_read_b128 v[100:103], v35 offset:752
    ds_read_b128 v[116:119], v33 offset:752
    s_waitcnt lgkmcnt(0)
    v_mfma_f32_32x32x16_bf16 v[128:143], v[68:71], v[100:103], v[128:143]
    v_mfma_f32_32x32x16_bf16 v[144:159], v[68:71], v[116:119], v[144:159]
    ds_read2_b32 v[72:73], v34 offset0:48 offset1:49
    ds_read2_b32 v[74:75], v34 offset0:50 offset1:51
    ds_read_b128 v[104:107], v35 offset:576
    ds_read_b128 v[120:123], v33 offset:576
    s_waitcnt lgkmcnt(0)
    v_mfma_f32_32x32x16_bf16 v[128:143], v[72:75], v[104:107], v[128:143]
    v_mfma_f32_32x32x16_bf16 v[144:159], v[72:75], v[120:123], v[144:159]
    ds_read2_b32 v[76:77], v34 offset0:56 offset1:57
    ds_read2_b32 v[78:79], v34 offset0:58 offset1:59
    ds_read_b128 v[108:111], v35 offset:608
    ds_read_b128 v[124:127], v33 offset:608
    s_waitcnt lgkmcnt(0)
    v_mfma_f32_32x32x16_bf16 v[128:143], v[76:79], v[108:111], v[128:143]
    v_mfma_f32_32x32x16_bf16 v[144:159], v[76:79], v[124:127], v[144:159]
    ds_read2_b32 v[48:49], v34 offset0:64 offset1:65
    ds_read2_b32 v[50:51], v34 offset0:66 offset1:67
    ds_read_b128 v[80:83], v35 offset:432
    ds_read_b128 v[112:115], v33 offset:432
    s_waitcnt lgkmcnt(0)
    v_mfma_f32_32x32x16_bf16 v[128:143], v[48:51], v[80:83], v[128:143]
    v_mfma_f32_32x32x16_bf16 v[144:159], v[48:51], v[112:115], v[144:159]
    ds_read2_b32 v[52:53], v34 offset0:72 offset1:73
    ds_read2_b32 v[54:55], v34 offset0:74 offset1:75
    ds_read_b128 v[84:87], v35 offset:464
    ds_read_b128 v[116:119], v33 offset:464
    s_waitcnt lgkmcnt(0)
    v_mfma_f32_32x32x16_bf16 v[128:143], v[52:55], v[84:87], v[128:143]
    v_mfma_f32_32x32x16_bf16 v[144:159], v[52:55], v[116:119], v[144:159]
    ds_read2_b32 v[56:57], v34 offset0:80 offset1:81
    ds_read2_b32 v[58:59], v34 offset0:82 offset1:83
    ds_read_b128 v[88:91], v35 offset:288
    ds_read_b128 v[120:123], v33 offset:288
    s_waitcnt lgkmcnt(0)
    v_mfma_f32_32x32x16_bf16 v[128:143], v[56:59], v[88:91], v[128:143]
    v_mfma_f32_32x32x16_bf16 v[144:159], v[56:59], v[120:123], v[144:159]
    ds_read2_b32 v[60:61], v34 offset0:88 offset1:89
    ds_read2_b32 v[62:63], v34 offset0:90 offset1:91
    ds_read_b128 v[92:95], v35 offset:320
    ds_read_b128 v[124:127], v33 offset:320
    s_waitcnt lgkmcnt(0)
    v_mfma_f32_32x32x16_bf16 v[128:143], v[60:63], v[92:95], v[128:143]
    v_mfma_f32_32x32x16_bf16 v[144:159], v[60:63], v[124:127], v[144:159]
    ds_read2_b32 v[64:65], v34 offset0:96 offset1:97
    ds_read2_b32 v[66:67], v34 offset0:98 offset1:99
    ds_read_b128 v[96:99], v35 offset:144
    ds_read_b128 v[112:115], v33 offset:144
    s_waitcnt lgkmcnt(0)
    v_mfma_f32_32x32x16_bf16 v[128:143], v[64:67], v[96:99], v[128:143]
    v_mfma_f32_32x32x16_bf16 v[144:159], v[64:67], v[112:115], v[144:159]
    ds_read2_b32 v[68:69], v34 offset0:104 offset1:105
    ds_read2_b32 v[70:71], v34 offset0:106 offset1:107
    ds_read_b128 v[100:103], v35 offset:176
    ds_read_b128 v[116:119], v33 offset:176
    s_waitcnt lgkmcnt(0)
    v_mfma_f32_32x32x16_bf16 v[128:143], v[68:71], v[100:103], v[128:143]
    v_mfma_f32_32x32x16_bf16 v[144:159], v[68:71], v[116:119], v[144:159]
    ds_read2_b32 v[72:73], v34 offset0:112 offset1:113
    ds_read2_b32 v[74:75], v34 offset0:114 offset1:115
    ds_read_b128 v[104:107], v35 offset:0
    ds_read_b128 v[120:123], v33 offset:0
    s_waitcnt lgkmcnt(0)
    v_mfma_f32_32x32x16_bf16 v[128:143], v[72:75], v[104:107], v[128:143]
    v_mfma_f32_32x32x16_bf16 v[144:159], v[72:75], v[120:123], v[144:159]
    ds_read2_b32 v[76:77], v34 offset0:120 offset1:121
    ds_read2_b32 v[78:79], v34 offset0:122 offset1:123
    ds_read_b128 v[108:111], v35 offset:32
    ds_read_b128 v[124:127], v33 offset:32
    s_waitcnt lgkmcnt(0)
    v_mfma_f32_32x32x16_bf16 v[128:143], v[76:79], v[108:111], v[128:143]
    v_mfma_f32_32x32x16_bf16 v[144:159], v[76:79], v[124:127], v[144:159]
    s_sub_u32 s72, s72, 1
    s_cmp_lg_u32 s72, 0
    s_cbranch_scc1 h_conv2
    s_lshl_b32 s63, s67, 2
    v_add_u32 v9, s63, v3
    s_waitcnt lgkmcnt(0)
    s_mov_b32 s75, 0x100000
lw5:
    ds_read_b32 v16, v9 offset:32
    s_sub_u32 s75, s75, 1
    s_waitcnt lgkmcnt(0)
    v_readfirstlane_b32 s74, v16
    s_nop 0
    s_cmp_ge_u32 s74, 1
    s_cbranch_scc1 lw5_ok
    s_sleep 1
    s_cmp_lg_u32 s75, 0
    s_cbranch_scc1 lw5
lw5_ok:
    ds_write_b128 v27, v[144:147] offset:4160
    ds_write_b128 v27, v[148:151] offset:5184
    ds_write_b128 v27, v[152:155] offset:6208
    ds_write_b128 v27, v[156:159] offset:7232
    s_waitcnt lgkmcnt(0)
    s_mov_b64 exec, 1
    ds_add_u32 v9, v14 offset:24
    s_mov_b64 exec, -1
    s_branch h_cepi
h_convb:
    s_lshl_b32 s63, s67, 2
    v_add_u32 v9, s63, v3
    s_waitcnt lgkmcnt(0)
    s_mov_b64 exec, 1
    ds_add_u32 v9, v14 offset:32
    s_mov_b64 exec, -1
    s_mov_b32 s75, 0x100000
lw6:
    ds_read_b32 v16, v9 offset:24
    s_sub_u32 s75, s75, 1
    s_waitcnt lgkmcnt(0)
    v_readfirstlane_b32 s74, v16
    s_nop 0
    s_cmp_ge_u32 s74, 1
    s_cbranch_scc1 lw6_ok
    s_sleep 1
    s_cmp_lg_u32 s75, 0
    s_cbranch_scc1 lw6
lw6_ok:
    ds_read_b128 v[144:147], v27 offset:4160
    ds_read_b128 v[148:151], v27 offset:5184
    ds_read_b128 v[152:155], v27 offset:6208
    ds_read_b128 v[156:159], v27 offset:7232
    s_waitcnt lgkmcnt(0)
    v_pk_add_f32 v[128:129], v[128:129], v[144:145]
    v_pk_add_f32 v[130:131], v[130:131], v[146:147]
    v_pk_add_f32 v[132:133], v[132:133], v[148:149]
    v_pk_add_f32 v[134:135], v[134:135], v[150:151]
    v_pk_add_f32 v[136:137], v[136:137], v[152:153]
    v_pk_add_f32 v[138:139], v[138:139], v[154:155]
    v_pk_add_f32 v[140:141], v[140:141], v[156:157]
    v_pk_add_f32 v[142:143], v[142:143], v[158:159]
h_cepi:
    s_setprio 3
    ds_read_b64 v[48:49], v22 offset:48
    ds_read_b64 v[50:51], v22 offset:32
    ds_read_b64 v[52:53], v22 offset:16
    ds_read_b64 v[54:55], v22 offset:0
    v_lshlrev_b32 v24, 16, v25
    s_waitcnt lgkmcnt(0)
    v_and_b32 v36, 0xffff0000, v49
    v_lshlrev_b32 v37, 16, v49
    v_and_b32 v38, 0xffff0000, v48
    v_lshlrev_b32 v39, 16, v48
    v_pk_fma_f32 v[128:129], v[36:37], v[24:25], v[128:129] op_sel_hi:[1,0,1]
    v_pk_fma_f32 v[130:131], v[38:39], v[24:25], v[130:131] op_sel_hi:[1,0,1]
    v_cvt_pk_bf16_f32 v40, v128, v129
    v_cvt_pk_bf16_f32 v41, v130, v131
    v_and_b32 v36, 0xffff0000, v51
    v_lshlrev_b32 v37, 16, v51
    v_and_b32 v38, 0xffff0000, v50
    v_lshlrev_b32 v39, 16, v50
    v_pk_fma_f32 v[132:133], v[36:37], v[24:25], v[132:133] op_sel_hi:[1,0,1]
    v_pk_fma_f32 v[134:135], v[38:39], v[24:25], v[134:135] op_sel_hi:[1,0,1]
    v_cvt_pk_bf16_f32 v42, v132, v133
    v_cvt_pk_bf16_f32 v43, v134, v135
    v_and_b32 v36, 0xffff0000, v53
    v_lshlrev_b32 v37, 16, v53
    v_and_b32 v38, 0xffff0000, v52
    v_lshlrev_b32 v39, 16, v52
    v_pk_fma_f32 v[136:137], v[36:37], v[24:25], v[136:137] op_sel_hi:[1,0,1]
    v_pk_fma_f32 v[138:139], v[38:39], v[24:25], v[138:139] op_sel_hi:[1,0,1]
    v_cvt_pk_bf16_f32 v44, v136, v137
    v_cvt_pk_bf16_f32 v45, v138, v139
    v_and_b32 v36, 0xffff0000, v55
    v_lshlrev_b32 v37, 16, v55
    v_and_b32 v38, 0xffff0000, v54
    v_lshlrev_b32 v39, 16, v54
    v_pk_fma_f32 v[140:141], v[36:37], v[24:25], v[140:141] op_sel_hi:[1,0,1]
    v_pk_fma_f32 v[142:143], v[38:39], v[24:25], v[142:143] op_sel_hi:[1,0,1]
    v_cvt_pk_bf16_f32 v46, v140, v141
    v_cvt_pk_bf16_f32 v47, v142, v143
    v_permlane32_swap_b32 v40, v42
    v_permlane32_swap_b32 v41, v43
    v_permlane32_swap_b32 v44, v46
    v_permlane32_swap_b32 v45, v47
    v_mov_b32 v56, v40
    v_mov_b32 v57, v41
    v_mov_b32 v58, v42
    v_mov_b32 v59, v43
    v_mov_b32_dpp v40, v44 row_shr:4 row_mask:0xf bank_mask:0xa
    v_mov_b32_dpp v44, v56 row_shl:4 row_mask:0xf bank_mask:0x5
    v_mov_b32_dpp v41, v45 row_shr:4 row_mask:0xf bank_mask:0xa
    v_mov_b32_dpp v45, v57 row_shl:4 row_mask:0xf bank_mask:0x5
    v_mov_b32_dpp v42, v46 row_shr:4 row_mask:0xf bank_mask:0xa
    v_mov_b32_dpp v46, v58 row_shl:4 row_mask:0xf bank_mask:0x5
    v_mov_b32_dpp v43, v47 row_shr:4 row_mask:0xf bank_mask:0xa
    v_mov_b32_dpp v47, v59 row_shl:4 row_mask:0xf bank_mask:0x5
    buffer_store_dwordx4 v[40:43], v23, s[44:47], 0 offen offset:0 sc1
    buffer_store_dwordx4 v[44:47], v23, s[44:47], 0 offen offset:256 sc1
    s_add_u32 s73, s65, 196608
    s_mov_b32 s75, 0x100000
lw7:
    ds_read_b32 v16, v3 offset:44
    s_sub_u32 s75, s75, 1
    s_waitcnt lgkmcnt(0)
    v_readfirstlane_b32 s74, v16
    s_nop 0
    s_cmp_ge_u32 s74, 8
    s_cbranch_scc1 lw7_ok
    s_sleep 1
    s_cmp_lg_u32 s75, 0
    s_cbranch_scc1 lw7
lw7_ok:
    s_waitcnt vmcnt(0)
    s_mov_b64 exec, 1
    ds_add_rtn_u32 v16, v3, v14 offset:20
    s_waitcnt lgkmcnt(0)
    v_readfirstlane_b32 s74, v16
    s_nop 0
    s_cmp_lg_u32 s74, 3
    s_cbranch_scc1 pb8
    v_mov_b32 v16, s77
    v_mov_b32 v18, 0
    s_getreg_b32 s74, hwreg(HW_REG_XCC_ID)
    v_mov_b32 v17, s74
    buffer_store_dwordx2 v[16:17], v18, s[32:35], s73 offen sc1
pb8:
    s_mov_b64 exec, -1
    s_mov_b32 s75, 0x100000
lw9:
    ds_read_b32 v16, v3 offset:12
    s_sub_u32 s75, s75, 1
    s_waitcnt lgkmcnt(0)
    v_readfirstlane_b32 s74, v16
    s_nop 0
    s_cmp_ge_u32 s74, 8
    s_cbranch_scc1 lw9_ok
    s_sleep 4
    s_cmp_lg_u32 s75, 0
    s_cbranch_scc1 lw9
lw9_ok:
    s_mul_i32 s72, s58, 16640
    s_add_u32 s63, s58, 4
    s_and_b32 s63, s63, 7
    s_mul_i32 s73, s63, 16640
    s_lshl_b32 s63, s66, 12
    s_add_u32 s72, s72, s63
    s_add_u32 s73, s73, s63
    s_lshl_b32 s67, s66, 15
    s_add_u32 s63, s72, 0
    s_mov_b32 m0, s63
    s_nop 0
    buffer_load_dwordx4 v8, s[36:39], s67 offen  lds
    s_add_u32 s67, s67, 8192
    s_add_u32 s63, s72, 1024
    s_mov_b32 m0, s63
    s_nop 0
    buffer_load_dwordx4 v8, s[36:39], s67 offen  lds
    s_add_u32 s67, s67, 8192
    s_add_u32 s63, s72, 2048
    s_mov_b32 m0, s63
    s_nop 0
    buffer_load_dwordx4 v8, s[36:39], s67 offen  lds
    s_add_u32 s67, s67, 8192
    s_add_u32 s63, s72, 3072
    s_mov_b32 m0, s63
    s_nop 0
    buffer_load_dwordx4 v8, s[36:39], s67 offen  lds
    s_add_u32 s67, s67, 106496
    s_add_u32 s63, s72, 16384
    s_mov_b32 m0, s63
    s_nop 0
    buffer_load_dwordx4 v8, s[36:39], s67 offen  lds
    s_add_u32 s67, s67, 8192
    s_add_u32 s63, s72, 17408
    s_mov_b32 m0, s63
    s_nop 0
    buffer_load_dwordx4 v8, s[36:39], s67 offen  lds
    s_add_u32 s67, s67, 8192
    s_add_u32 s63, s72, 18432
    s_mov_b32 m0, s63
    s_nop 0
    buffer_load_dwordx4 v8, s[36:39], s67 offen  lds
    s_add_u32 s67, s67, 8192
    s_add_u32 s63, s72, 19456
    s_mov_b32 m0, s63
    s_nop 0
    buffer_load_dwordx4 v8, s[36:39], s67 offen  lds
    s_add_u32 s67, s67, 106496
    s_add_u32 s63, s73, 0
    s_mov_b32 m0, s63
    s_nop 0
    buffer_load_dwordx4 v8, s[36:39], s67 offen  lds
    s_add_u32 s67, s67, 8192
    s_add_u32 s63, s73, 1024
    s_mov_b32 m0, s63
    s_nop 0
    buffer_load_dwordx4 v8, s[36:39], s67 offen  lds
    s_add_u32 s67, s67, 8192
    s_add_u32 s63, s73, 2048
    s_mov_b32 m0, s63
    s_nop 0
    buffer_load_dwordx4 v8, s[36:39], s67 offen  lds
    s_add_u32 s67, s67, 8192
    s_add_u32 s63, s73, 3072
    s_mov_b32 m0, s63
    s_nop 0
    buffer_load_dwordx4 v8, s[36:39], s67 offen  lds
    s_add_u32 s67, s67, 106496
    s_add_u32 s63, s73, 16384
    s_mov_b32 m0, s63
    s_nop 0
    buffer_load_dwordx4 v8, s[36:39], s67 offen  lds
    s_add_u32 s67, s67, 8192
    s_add_u32 s63, s73, 17408
    s_mov_b32 m0, s63
    s_nop 0
    buffer_load_dwordx4 v8, s[36:39], s67 offen  lds
    s_add_u32 s67, s67, 8192
    s_add_u32 s63, s73, 18432
    s_mov_b32 m0, s63
    s_nop 0
    buffer_load_dwordx4 v8, s[36:39], s67 offen  lds
    s_add_u32 s67, s67, 8192
    s_add_u32 s63, s73, 19456
    s_mov_b32 m0, s63
    s_nop 0
    buffer_load_dwordx4 v8, s[36:39], s67 offen  lds
    s_add_u32 s67, s67, 106496
    s_waitcnt vmcnt(0)
    s_endpgm
a_gate:
    v_lshrrev_b32 v8, 4, v1
    v_lshlrev_b32 v8, 4, v8
    s_waitcnt lgkmcnt(0)
    s_mov_b32 s32, s34
    s_mov_b32 s33, s35
    s_mov_b32 s34, 7340032
    s_mov_b32 s35, 0x20000
    s_mov_b32 s52, s28
    s_mov_b32 s53, s29
    s_mov_b32 s54, 1024
    s_mov_b32 s55, 0x20000
    s_add_u32 s63, s59, 0
    s_and_b32 s63, s63, 3
    s_lshl_b32 s63, s63, 8
    buffer_load_dwordx4 v[64:67], v8, s[52:55], s63 offen offset:0
    buffer_load_dwordx4 v[68:71], v8, s[52:55], s63 offen offset:64
    buffer_load_dwordx4 v[72:75], v8, s[52:55], s63 offen offset:128
    buffer_load_dwordx4 v[76:79], v8, s[52:55], s63 offen offset:192
    s_add_u32 s63, s59, 1
    s_and_b32 s63, s63, 3
    s_lshl_b32 s63, s63, 8
    buffer_load_dwordx4 v[80:83], v8, s[52:55], s63 offen offset:0
    buffer_load_dwordx4 v[84:87], v8, s[52:55], s63 offen offset:64
    buffer_load_dwordx4 v[88:91], v8, s[52:55], s63 offen offset:128
    buffer_load_dwordx4 v[92:95], v8, s[52:55], s63 offen offset:192
    s_add_u32 s63, s59, 2
    s_and_b32 s63, s63, 3
    s_lshl_b32 s63, s63, 8
    buffer_load_dwordx4 v[96:99], v8, s[52:55], s63 offen offset:0
    buffer_load_dwordx4 v[100:103], v8, s[52:55], s63 offen offset:64
    buffer_load_dwordx4 v[104:107], v8, s[52:55], s63 offen offset:128
    buffer_load_dwordx4 v[108:111], v8, s[52:55], s63 offen offset:192
    s_add_u32 s63, s59, 3
    s_and_b32 s63, s63, 3
    s_lshl_b32 s63, s63, 8
    buffer_load_dwordx4 v[112:115], v8, s[52:55], s63 offen offset:0
    buffer_load_dwordx4 v[116:119], v8, s[52:55], s63 offen offset:64
    buffer_load_dwordx4 v[120:123], v8, s[52:55], s63 offen offset:128
    buffer_load_dwordx4 v[124:127], v8, s[52:55], s63 offen offset:192
    v_and_b32 v17, 15, v1
    v_lshrrev_b32 v18, 4, v1
    v_xor_b32 v19, v17, v18
    v_lshlrev_b32 v19, 4, v19
    v_lshl_add_u32 v19, v17, 8, v19
    s_lshl_b32 s63, s76, 12
    v_add_u32 v20, s63, v19
    v_xor_b32 v21, 64, v20
    v_xor_b32 v22, 128, v20
    v_xor_b32 v23, 192, v20
    s_lshl_b32 s65, s60, 2
    s_add_u32 s65, s65, s76
    s_lshl_b32 s67, s65, 6
    s_add_u32 s67, s67, 151552
    v_lshlrev_b32 v25, 2, v1
    s_barrier
    ds_read_b128 v[32:35], v20 offset:0
    ds_read_b128 v[36:39], v21 offset:0
    ds_read_b128 v[40:43], v22 offset:0
    ds_read_b128 v[44:47], v23 offset:0
    ds_read_b128 v[48:51], v20 offset:16384
    ds_read_b128 v[52:55], v21 offset:16384
    ds_read_b128 v[56:59], v22 offset:16384
    ds_read_b128 v[60:63], v23 offset:16384
    s_waitcnt vmcnt(0)
    s_waitcnt lgkmcnt(7)
    v_mfma_f32_16x16x32_bf16 v[4:7], v[64:67], v[32:35], 0
    ds_read_b128 v[32:35], v20 offset:32768
    s_waitcnt lgkmcnt(7)
    v_mfma_f32_16x16x32_bf16 v[4:7], v[68:71], v[36:39], v[4:7]
    ds_read_b128 v[36:39], v21 offset:32768
    s_waitcnt lgkmcnt(7)
    v_mfma_f32_16x16x32_bf16 v[4:7], v[72:75], v[40:43], v[4:7]
    ds_read_b128 v[40:43], v22 offset:32768
    s_waitcnt lgkmcnt(7)
    v_mfma_f32_16x16x32_bf16 v[4:7], v[76:79], v[44:47], v[4:7]
    ds_read_b128 v[44:47], v23 offset:32768
    s_waitcnt lgkmcnt(7)
    v_mfma_f32_16x16x32_bf16 v[4:7], v[80:83], v[48:51], v[4:7]
    ds_read_b128 v[48:51], v20 offset:49152
    s_waitcnt lgkmcnt(7)
    v_mfma_f32_16x16x32_bf16 v[4:7], v[84:87], v[52:55], v[4:7]
    ds_read_b128 v[52:55], v21 offset:49152
    s_waitcnt lgkmcnt(7)
    v_mfma_f32_16x16x32_bf16 v[4:7], v[88:91], v[56:59], v[4:7]
    ds_read_b128 v[56:59], v22 offset:49152
    s_waitcnt lgkmcnt(7)
    v_mfma_f32_16x16x32_bf16 v[4:7], v[92:95], v[60:63], v[4:7]
    ds_read_b128 v[60:63], v23 offset:49152
    s_waitcnt lgkmcnt(7)
    v_mfma_f32_16x16x32_bf16 v[4:7], v[96:99], v[32:35], v[4:7]
    s_waitcnt lgkmcnt(6)
    v_mfma_f32_16x16x32_bf16 v[4:7], v[100:103], v[36:39], v[4:7]
    s_waitcnt lgkmcnt(5)
    v_mfma_f32_16x16x32_bf16 v[4:7], v[104:107], v[40:43], v[4:7]
    s_waitcnt lgkmcnt(4)
    v_mfma_f32_16x16x32_bf16 v[4:7], v[108:111], v[44:47], v[4:7]
    s_waitcnt lgkmcnt(3)
    v_mfma_f32_16x16x32_bf16 v[4:7], v[112:115], v[48:51], v[4:7]
    s_waitcnt lgkmcnt(2)
    v_mfma_f32_16x16x32_bf16 v[4:7], v[116:119], v[52:55], v[4:7]
    s_waitcnt lgkmcnt(1)
    v_mfma_f32_16x16x32_bf16 v[4:7], v[120:123], v[56:59], v[4:7]
    s_waitcnt lgkmcnt(0)
    v_mfma_f32_16x16x32_bf16 v[4:7], v[124:127], v[60:63], v[4:7]
    s_mov_b32 s63, 0xbfb8aa3b
    s_nop 6
    v_mul_f32 v10, s63, v4
    v_exp_f32 v10, v10
    s_nop 0
    v_add_f32 v10, 1.0, v10
    v_rcp_f32 v10, v10
    s_mov_b64 exec, 0xffff
    buffer_store_dword v10, v25, s[32:35], s67 offen sc1
    s_mov_b64 exec, -1
a_late2:
    s_mov_b32 s17, 1
    s_waitcnt lgkmcnt(0)
    s_barrier
a_late:
    s_nop 0
    s_lshr_b32 s63, s3, 2
    s_lshl_b32 s62, s60, 1
    s_add_u32 s62, s62, s63
    s_lshl_b32 s62, s62, 5
    s_lshl_b32 s63, s61, 2
    s_add_u32 s62, s62, s63
    s_and_b32 s63, s3, 3
    s_add_u32 s62, s62, s63
    s_lshl_b32 s62, s62, 10
    s_add_u32 s62, s62, 3145728
    v_mov_b32 v153, 149760
    s_mov_b32 s36, s4
    s_mov_b32 s37, s5
    s_mov_b32 s38, 2097152
    s_mov_b32 s39, 0x20000
    s_mov_b32 s40, s30
    s_mov_b32 s41, s31
    s_mov_b32 s42, 2097152
    s_mov_b32 s43, 0x20000
    s_and_b32 s64, s3, 4
    s_add_u32 s71, s58, s64
    s_and_b32 s71, s71, 7
    s_mul_i32 s59, s71, 65
    s_lshr_b32 s59, s59, 2
    s_and_b32 s64, s3, 3
    s_add_u32 s59, s59, s64
    s_mov_b32 s65, 147456
    v_and_b32 v157, 31, v1
    v_lshrrev_b32 v3, 5, v1
    v_and_b32 v158, 15, v1
    v_lshlrev_b32 v158, 4, v158
    v_lshl_add_u32 v158, v3, 8, v158
    v_add_u32 v158, 1024, v158
    v_mov_b32 v152, 0x100000
    v_and_b32 v159, 27, v157
    v_cmp_eq_u32 vcc, 16, v159
    v_mov_b32 v159, 1536
    s_nop 0
    v_cndmask_b32 v152, v152, v159, vcc
    v_cmp_gt_u32 vcc, 16, v157
    s_mul_i32 s70, s71, 16640
    s_nop 0
    v_cndmask_b32 v152, v152, v158, vcc
    v_add_u32 v148, s70, v2
    v_add_u32 v149, s70, v152
    s_add_u32 s71, s71, 1
    s_and_b32 s71, s71, 7
    s_mul_i32 s70, s71, 16640
    v_add_u32 v150, s70, v2
    v_add_u32 v151, s70, v152
    s_lshl_b32 s63, s64, 11
    s_add_u32 s63, s63, 149824
    v_add_u32 v158, s63, v2
    v_lshlrev_b32 v155, 3, v1
    v_pk_mov_b32 v[84:85], 0, 0
    v_pk_mov_b32 v[86:87], 0, 0
    v_pk_mov_b32 v[88:89], 0, 0
    v_pk_mov_b32 v[90:91], 0, 0
    v_pk_mov_b32 v[92:93], 0, 0
    v_pk_mov_b32 v[94:95], 0, 0
    v_pk_mov_b32 v[96:97], 0, 0
    v_pk_mov_b32 v[98:99], 0, 0
    v_pk_mov_b32 v[100:101], 0, 0
    v_pk_mov_b32 v[102:103], 0, 0
    v_pk_mov_b32 v[104:105], 0, 0
    v_pk_mov_b32 v[106:107], 0, 0
    v_pk_mov_b32 v[108:109], 0, 0
    v_pk_mov_b32 v[110:111], 0, 0
    v_pk_mov_b32 v[112:113], 0, 0
    v_pk_mov_b32 v[114:115], 0, 0
    v_pk_mov_b32 v[116:117], 0, 0
    v_pk_mov_b32 v[118:119], 0, 0
    v_pk_mov_b32 v[120:121], 0, 0
    v_pk_mov_b32 v[122:123], 0, 0
    v_pk_mov_b32 v[140:141], 0, 0
    v_pk_mov_b32 v[142:143], 0, 0
    v_pk_mov_b32 v[144:145], 0, 0
    v_pk_mov_b32 v[146:147], 0, 0
    s_cmp_lt_u32 s3, 4
    s_cbranch_scc1 a_gemm
    s_cmp_eq_u32 s17, 1
    s_cbranch_scc1 a_late3
    s_barrier
a_late3:
    s_waitcnt vmcnt(0)
    s_barrier
    s_barrier
    s_branch a_common
a_gemm:
    s_lshr_b32 s63, s3, 1
    s_lshl_b32 s63, s63, 13
    v_and_b32 v8, 31, v1
    v_lshrrev_b32 v9, 5, v1
    v_and_b32 v10, 15, v1
    v_xor_b32 v10, v10, v9
    v_lshlrev_b32 v10, 4, v10
    v_lshl_add_u32 v10, v8, 8, v10
    v_add_u32 v124, s63, v10
    v_xor_b32 v125, 32, v124
    v_xor_b32 v126, 64, v124
    v_xor_b32 v127, 96, v124
    v_xor_b32 v128, 128, v124
    v_xor_b32 v129, 160, v124
    v_xor_b32 v130, 192, v124
    v_xor_b32 v131, 224, v124
    s_and_b32 s63, s3, 1
    v_bfe_u32 v8, v1, 2, 2
    v_lshrrev_b32 v10, 1, v8
    v_xor_b32 v10, s63, v10
    v_lshlrev_b32 v10, 6, v10
    v_lshl_add_u32 v8, v9, 3, v8
    v_lshl_add_u32 v10, v8, 7, v10
    v_bfe_u32 v8, v1, 4, 1
    v_lshl_add_u32 v10, v8, 5, v10
    v_and_b32 v8, 3, v1
    v_lshl_add_u32 v10, v8, 3, v10
    v_add_u32 v132, 65536, v10
    s_lshl_b32 s63, s63, 12
    s_lshr_b32 s64, s3, 1
    s_lshl_b32 s64, s64, 10
    s_add_u32 s63, s63, s64
    s_add_u32 s63, s63, 149824
    v_add_u32 v133, s63, v2
    s_barrier
    ds_read_b128 v[36:39], v124 offset:0
    ds_read_b64_tr_b16 v[4:5], v132 offset:0
    ds_read_b64_tr_b16 v[6:7], v132 offset:512
    ds_read_b128 v[40:43], v125 offset:0
    ds_read_b64_tr_b16 v[8:9], v132 offset:2048
    ds_read_b64_tr_b16 v[10:11], v132 offset:2560
    ds_read_b128 v[44:47], v126 offset:0
    ds_read_b64_tr_b16 v[12:13], v132 offset:4096
    ds_read_b64_tr_b16 v[14:15], v132 offset:4608
    ds_read_b128 v[48:51], v127 offset:0
    ds_read_b64_tr_b16 v[16:17], v132 offset:6144
    ds_read_b64_tr_b16 v[18:19], v132 offset:6656
    ds_read_b128 v[52:55], v128 offset:0
    ds_read_b64_tr_b16 v[20:21], v132 offset:8192
    ds_read_b64_tr_b16 v[22:23], v132 offset:8704
    s_waitcnt lgkmcnt(12)
    v_mfma_f32_32x32x16_bf16 v[68:83], v[4:7], v[36:39], 0
    ds_read_b128 v[56:59], v129 offset:0
    ds_read_b64_tr_b16 v[24:25], v132 offset:10240
    ds_read_b64_tr_b16 v[26:27], v132 offset:10752
    s_waitcnt lgkmcnt(12)
    v_mfma_f32_32x32x16_bf16 v[68:83], v[8:11], v[40:43], v[68:83]
    ds_read_b128 v[60:63], v130 offset:0
    ds_read_b64_tr_b16 v[28:29], v132 offset:12288
    ds_read_b64_tr_b16 v[30:31], v132 offset:12800
    s_waitcnt lgkmcnt(12)
    v_mfma_f32_32x32x16_bf16 v[68:83], v[12:15], v[44:47], v[68:83]
    ds_read_b128 v[64:67], v131 offset:0
    ds_read_b64_tr_b16 v[32:33], v132 offset:14336
    ds_read_b64_tr_b16 v[34:35], v132 offset:14848
    s_waitcnt lgkmcnt(12)
    v_mfma_f32_32x32x16_bf16 v[68:83], v[16:19], v[48:51], v[68:83]
    ds_read_b128 v[36:39], v124 offset:16384
    ds_read_b64_tr_b16 v[4:5], v132 offset:16384
    ds_read_b64_tr_b16 v[6:7], v132 offset:16896
    s_waitcnt lgkmcnt(12)
    v_mfma_f32_32x32x16_bf16 v[68:83], v[20:23], v[52:55], v[68:83]
    ds_read_b128 v[40:43], v125 offset:16384
    ds_read_b64_tr_b16 v[8:9], v132 offset:18432
    ds_read_b64_tr_b16 v[10:11], v132 offset:18944
    s_waitcnt lgkmcnt(12)
    v_mfma_f32_32x32x16_bf16 v[68:83], v[24:27], v[56:59], v[68:83]
    ds_read_b128 v[44:47], v126 offset:16384
    ds_read_b64_tr_b16 v[12:13], v132 offset:20480
    ds_read_b64_tr_b16 v[14:15], v132 offset:20992
    s_waitcnt lgkmcnt(12)
    v_mfma_f32_32x32x16_bf16 v[68:83], v[28:31], v[60:63], v[68:83]
    ds_read_b128 v[48:51], v127 offset:16384
    ds_read_b64_tr_b16 v[16:17], v132 offset:22528
    ds_read_b64_tr_b16 v[18:19], v132 offset:23040
    s_waitcnt lgkmcnt(12)
    v_mfma_f32_32x32x16_bf16 v[68:83], v[32:35], v[64:67], v[68:83]
    ds_read_b128 v[52:55], v128 offset:16384
    ds_read_b64_tr_b16 v[20:21], v132 offset:24576
    ds_read_b64_tr_b16 v[22:23], v132 offset:25088
    s_waitcnt lgkmcnt(12)
    v_mfma_f32_32x32x16_bf16 v[68:83], v[4:7], v[36:39], v[68:83]
    ds_read_b128 v[56:59], v129 offset:16384
    ds_read_b64_tr_b16 v[24:25], v132 offset:26624
    ds_read_b64_tr_b16 v[26:27], v132 offset:27136
    s_waitcnt lgkmcnt(12)
    v_mfma_f32_32x32x16_bf16 v[68:83], v[8:11], v[40:43], v[68:83]
    ds_read_b128 v[60:63], v130 offset:16384
    ds_read_b64_tr_b16 v[28:29], v132 offset:28672
    ds_read_b64_tr_b16 v[30:31], v132 offset:29184
    s_waitcnt lgkmcnt(12)
    v_mfma_f32_32x32x16_bf16 v[68:83], v[12:15], v[44:47], v[68:83]
    ds_read_b128 v[64:67], v131 offset:16384
    ds_read_b64_tr_b16 v[32:33], v132 offset:30720
    ds_read_b64_tr_b16 v[34:35], v132 offset:31232
    s_waitcnt lgkmcnt(12)
    v_mfma_f32_32x32x16_bf16 v[68:83], v[16:19], v[48:51], v[68:83]
    s_waitcnt lgkmcnt(9)
    v_mfma_f32_32x32x16_bf16 v[68:83], v[20:23], v[52:55], v[68:83]
    s_waitcnt lgkmcnt(6)
    v_mfma_f32_32x32x16_bf16 v[68:83], v[24:27], v[56:59], v[68:83]
    s_waitcnt lgkmcnt(3)
    v_mfma_f32_32x32x16_bf16 v[68:83], v[28:31], v[60:63], v[68:83]
    s_waitcnt lgkmcnt(0)
    v_mfma_f32_32x32x16_bf16 v[68:83], v[32:35], v[64:67], v[68:83]
    s_barrier
    ds_read_b128 v[36:39], v124 offset:32768
    ds_read_b64_tr_b16 v[4:5], v132 offset:32768
    ds_read_b64_tr_b16 v[6:7], v132 offset:33280
    ds_read_b128 v[40:43], v125 offset:32768
    ds_read_b64_tr_b16 v[8:9], v132 offset:34816
    ds_read_b64_tr_b16 v[10:11], v132 offset:35328
    ds_read_b128 v[44:47], v126 offset:32768
    ds_read_b64_tr_b16 v[12:13], v132 offset:36864
    ds_read_b64_tr_b16 v[14:15], v132 offset:37376
    ds_read_b128 v[48:51], v127 offset:32768
    ds_read_b64_tr_b16 v[16:17], v132 offset:38912
    ds_read_b64_tr_b16 v[18:19], v132 offset:39424
    ds_read_b128 v[52:55], v128 offset:32768
    ds_read_b64_tr_b16 v[20:21], v132 offset:40960
    ds_read_b64_tr_b16 v[22:23], v132 offset:41472
    s_waitcnt lgkmcnt(12)
    v_mfma_f32_32x32x16_bf16 v[68:83], v[4:7], v[36:39], v[68:83]
    ds_read_b128 v[56:59], v129 offset:32768
    ds_read_b64_tr_b16 v[24:25], v132 offset:43008
    ds_read_b64_tr_b16 v[26:27], v132 offset:43520
    s_waitcnt lgkmcnt(12)
    v_mfma_f32_32x32x16_bf16 v[68:83], v[8:11], v[40:43], v[68:83]
    ds_read_b128 v[60:63], v130 offset:32768
    ds_read_b64_tr_b16 v[28:29], v132 offset:45056
    ds_read_b64_tr_b16 v[30:31], v132 offset:45568
    s_waitcnt lgkmcnt(12)
    v_mfma_f32_32x32x16_bf16 v[68:83], v[12:15], v[44:47], v[68:83]
    ds_read_b128 v[64:67], v131 offset:32768
    ds_read_b64_tr_b16 v[32:33], v132 offset:47104
    ds_read_b64_tr_b16 v[34:35], v132 offset:47616
    s_waitcnt lgkmcnt(12)
    v_mfma_f32_32x32x16_bf16 v[68:83], v[16:19], v[48:51], v[68:83]
    ds_read_b128 v[36:39], v124 offset:49152
    ds_read_b64_tr_b16 v[4:5], v132 offset:49152
    ds_read_b64_tr_b16 v[6:7], v132 offset:49664
    s_waitcnt lgkmcnt(12)
    v_mfma_f32_32x32x16_bf16 v[68:83], v[20:23], v[52:55], v[68:83]
    ds_read_b128 v[40:43], v125 offset:49152
    ds_read_b64_tr_b16 v[8:9], v132 offset:51200
    ds_read_b64_tr_b16 v[10:11], v132 offset:51712
    s_waitcnt lgkmcnt(12)
    v_mfma_f32_32x32x16_bf16 v[68:83], v[24:27], v[56:59], v[68:83]
    ds_read_b128 v[44:47], v126 offset:49152
    ds_read_b64_tr_b16 v[12:13], v132 offset:53248
    ds_read_b64_tr_b16 v[14:15], v132 offset:53760
    s_waitcnt lgkmcnt(12)
    v_mfma_f32_32x32x16_bf16 v[68:83], v[28:31], v[60:63], v[68:83]
    ds_read_b128 v[48:51], v127 offset:49152
    ds_read_b64_tr_b16 v[16:17], v132 offset:55296
    ds_read_b64_tr_b16 v[18:19], v132 offset:55808
    s_waitcnt lgkmcnt(12)
    v_mfma_f32_32x32x16_bf16 v[68:83], v[32:35], v[64:67], v[68:83]
    ds_read_b128 v[52:55], v128 offset:49152
    ds_read_b64_tr_b16 v[20:21], v132 offset:57344
    ds_read_b64_tr_b16 v[22:23], v132 offset:57856
    s_waitcnt lgkmcnt(12)
    v_mfma_f32_32x32x16_bf16 v[68:83], v[4:7], v[36:39], v[68:83]
    ds_read_b128 v[56:59], v129 offset:49152
    ds_read_b64_tr_b16 v[24:25], v132 offset:59392
    ds_read_b64_tr_b16 v[26:27], v132 offset:59904
    s_waitcnt lgkmcnt(12)
    v_mfma_f32_32x32x16_bf16 v[68:83], v[8:11], v[40:43], v[68:83]
    ds_read_b128 v[60:63], v130 offset:49152
    ds_read_b64_tr_b16 v[28:29], v132 offset:61440
    ds_read_b64_tr_b16 v[30:31], v132 offset:61952
    s_waitcnt lgkmcnt(12)
    v_mfma_f32_32x32x16_bf16 v[68:83], v[12:15], v[44:47], v[68:83]
    ds_read_b128 v[64:67], v131 offset:49152
    ds_read_b64_tr_b16 v[32:33], v132 offset:63488
    ds_read_b64_tr_b16 v[34:35], v132 offset:64000
    s_waitcnt lgkmcnt(12)
    v_mfma_f32_32x32x16_bf16 v[68:83], v[16:19], v[48:51], v[68:83]
    s_waitcnt lgkmcnt(9)
    v_mfma_f32_32x32x16_bf16 v[68:83], v[20:23], v[52:55], v[68:83]
    s_waitcnt lgkmcnt(6)
    v_mfma_f32_32x32x16_bf16 v[68:83], v[24:27], v[56:59], v[68:83]
    s_waitcnt lgkmcnt(3)
    v_mfma_f32_32x32x16_bf16 v[68:83], v[28:31], v[60:63], v[68:83]
    s_waitcnt lgkmcnt(0)
    v_mfma_f32_32x32x16_bf16 v[68:83], v[32:35], v[64:67], v[68:83]
    s_nop 11
    v_cvt_pk_bf16_f32 v4, v68, v69
    v_cvt_pk_bf16_f32 v5, v70, v71
    v_cvt_pk_bf16_f32 v6, v72, v73
    v_cvt_pk_bf16_f32 v7, v74, v75
    v_cvt_pk_bf16_f32 v8, v76, v77
    v_cvt_pk_bf16_f32 v9, v78, v79
    v_cvt_pk_bf16_f32 v10, v80, v81
    v_cvt_pk_bf16_f32 v11, v82, v83
    ds_write_b128 v133, v[4:7]
    ds_write_b128 v133, v[8:11] offset:2048
    s_waitcnt lgkmcnt(0)
    s_barrier
a_common:
    ds_read_b128 v[4:7], v158
    ds_read_b128 v[8:11], v158 offset:1024
    s_mov_b32 s75, 0x100000
lw10:
    ds_read_b32 v154, v153 offset:0
    s_sub_u32 s75, s75, 1
    s_waitcnt lgkmcnt(0)
    v_readfirstlane_b32 s74, v154
    s_nop 0
    s_cmp_ge_u32 s74, 1
    s_cbranch_scc1 lw10_ok
    s_sleep 1
    s_cmp_lg_u32 s75, 0
    s_cbranch_scc1 lw10
lw10_ok:
    buffer_load_dwordx2 v[156:157], v155, s[32:35], s65 offen sc1
    s_cmp_ge_u32 s59, 130
    s_cselect_b32 s63, 130, 0
    s_sub_u32 s59, s59, s63
    s_lshl_b32 s63, s59, 10
    s_add_u32 s59, s59, 4
    s_mov_b32 m0, s63
    s_nop 0
    buffer_load_dwordx4 v2, s[32:35], s63 offen sc1 lds
    s_cmp_ge_u32 s59, 130
    s_cselect_b32 s63, 130, 0
    s_sub_u32 s59, s59, s63
    s_lshl_b32 s63, s59, 10
    s_add_u32 s59, s59, 4
    s_mov_b32 m0, s63
    s_nop 0
    buffer_load_dwordx4 v2, s[32:35], s63 offen sc1 lds
    s_cmp_ge_u32 s59, 130
    s_cselect_b32 s63, 130, 0
    s_sub_u32 s59, s59, s63
    s_lshl_b32 s63, s59, 10
    s_add_u32 s59, s59, 4
    s_mov_b32 m0, s63
    s_nop 0
    buffer_load_dwordx4 v2, s[32:35], s63 offen sc1 lds
    v_dot2_f32_bf16 v160, v4, v4, 0
    v_dot2_f32_bf16 v161, v5, v5, 0
    v_dot2_f32_bf16 v162, v6, v6, 0
    v_dot2_f32_bf16 v163, v7, v7, 0
    v_dot2_f32_bf16 v164, v8, v8, 0
    v_dot2_f32_bf16 v165, v9, v9, 0
    v_dot2_f32_bf16 v166, v10, v10, 0
    v_dot2_f32_bf16 v167, v11, v11, 0
    v_mov_b32 v74, 0
    v_mov_b32 v75, 0
    v_add_f32 v160, v160, v161
    v_add_f32 v162, v162, v163
    v_add_f32 v164, v164, v165
    v_add_f32 v166, v166, v167
    v_add_f32 v160, v160, v162
    v_add_f32 v164, v164, v166
    v_mov_b32 v161, v160
    v_mov_b32 v165, v164
    s_nop 0
    v_permlane32_swap_b32 v160, v161
    v_permlane32_swap_b32 v164, v165
    v_add_f32 v160, v160, v161
    v_add_f32 v164, v164, v165
    s_waitcnt vmcnt(3)
    v_max_f32 v156, v156, v157
    s_nop 1
    v_max_f32_dpp v156, v156, v156 row_ror:8 row_mask:0xf bank_mask:0xf
    s_nop 1
    v_max_f32_dpp v156, v156, v156 row_ror:4 row_mask:0xf bank_mask:0xf
    s_nop 1
    v_max_f32_dpp v156, v156, v156 row_ror:2 row_mask:0xf bank_mask:0xf
    s_nop 1
    v_max_f32_dpp v156, v156, v156 row_ror:1 row_mask:0xf bank_mask:0xf
    v_mov_b32 v157, v156
    s_nop 1
    v_permlane32_swap_b32 v156, v157
    v_max_f32 v156, v156, v157
    v_mov_b32 v157, v156
    s_nop 1
    v_permlane16_swap_b32 v156, v157
    v_max_f32 v156, v156, v157
    v_mul_f32 v160, v160, v156
    v_mul_f32 v164, v164, v156
    s_mov_b32 s72, 0x44c80000
    v_cmp_nle_f32 vcc, v160, s72
    v_cmp_nle_f32 s[74:75], v164, s72
    v_sqrt_f32 v160, v160
    v_sqrt_f32 v164, v164
    s_or_b64 vcc, vcc, s[74:75]
    v_mov_b32 v155, 1
    s_waitcnt vmcnt(0)
    s_barrier
    s_cbranch_vccz a_fast
    s_mov_b32 s75, 0x100000
lw11:
    ds_read_b32 v154, v153 offset:60
    s_sub_u32 s75, s75, 1
    s_waitcnt lgkmcnt(0)
    v_readfirstlane_b32 s74, v154
    s_nop 0
    s_cmp_ge_u32 s74, 4
    s_cbranch_scc1 lw11_ok
    s_sleep 1
    s_cmp_lg_u32 s75, 0
    s_cbranch_scc1 lw11
lw11_ok:
    v_mov_b32 v160, 0xff800000
    v_mov_b32 v164, 0xff800000
    v_mov_b32 v154, v2
    s_mov_b32 s74, 64
a_maxloop:
    ds_read_b128 v[124:127], v154
    v_add_u32 v154, 2080, v154
    s_waitcnt lgkmcnt(0)
    v_mfma_f32_32x32x16_bf16 v[44:59], v[124:127], v[4:7], 0
    v_mfma_f32_32x32x16_bf16 v[12:27], v[124:127], v[8:11], 0
    s_nop 10
    v_max3_f32 v160, v160, v44, v45
    v_max3_f32 v160, v160, v46, v47
    v_max3_f32 v160, v160, v48, v49
    v_max3_f32 v160, v160, v50, v51
    v_max3_f32 v160, v160, v52, v53
    v_max3_f32 v160, v160, v54, v55
    v_max3_f32 v160, v160, v56, v57
    v_max3_f32 v160, v160, v58, v59
    v_max3_f32 v164, v164, v12, v13
    v_max3_f32 v164, v164, v14, v15
    v_max3_f32 v164, v164, v16, v17
    v_max3_f32 v164, v164, v18, v19
    v_max3_f32 v164, v164, v20, v21
    v_max3_f32 v164, v164, v22, v23
    v_max3_f32 v164, v164, v24, v25
    v_max3_f32 v164, v164, v26, v27
    s_sub_u32 s74, s74, 1
    s_cmp_lg_u32 s74, 0
    s_cbranch_scc1 a_maxloop
    v_mov_b32 v161, v160
    v_mov_b32 v165, v164
    s_nop 0
    v_permlane32_swap_b32 v160, v161
    v_permlane32_swap_b32 v164, v165
    v_max_f32 v160, v160, v161
    v_max_f32 v164, v164, v165
a_fast:
    ds_read_b128 v[124:127], v148
    ds_read_b128 v[128:131], v148 offset:2080
    ds_read_b128 v[132:135], v149
    ds_read_b128 v[136:139], v149 offset:528
    v_mov_b32 v76, -1
    v_mov_b32 v77, -1
    v_mov_b32 v78, -1
    v_mov_b32 v79, -1
    buffer_store_dwordx4 v[76:79], v2, s[32:35], s62 offen sc1
    v_sub_f32 v160, 0, v160
    v_sub_f32 v164, 0, v164
    v_pk_mov_b32 v[12:13], v[160:161], v[160:161] op_sel:[0,0]
    v_pk_mov_b32 v[14:15], v[160:161], v[160:161] op_sel:[0,0]
    v_pk_mov_b32 v[16:17], v[160:161], v[160:161] op_sel:[0,0]
    v_pk_mov_b32 v[18:19], v[160:161], v[160:161] op_sel:[0,0]
    v_pk_mov_b32 v[20:21], v[160:161], v[160:161] op_sel:[0,0]
    v_pk_mov_b32 v[22:23], v[160:161], v[160:161] op_sel:[0,0]
    v_pk_mov_b32 v[24:25], v[160:161], v[160:161] op_sel:[0,0]
    v_pk_mov_b32 v[26:27], v[160:161], v[160:161] op_sel:[0,0]
    v_pk_mov_b32 v[28:29], v[164:165], v[164:165] op_sel:[0,0]
    v_pk_mov_b32 v[30:31], v[164:165], v[164:165] op_sel:[0,0]
    v_pk_mov_b32 v[32:33], v[164:165], v[164:165] op_sel:[0,0]
    v_pk_mov_b32 v[34:35], v[164:165], v[164:165] op_sel:[0,0]
    v_pk_mov_b32 v[36:37], v[164:165], v[164:165] op_sel:[0,0]
    v_pk_mov_b32 v[38:39], v[164:165], v[164:165] op_sel:[0,0]
    v_pk_mov_b32 v[40:41], v[164:165], v[164:165] op_sel:[0,0]
    v_pk_mov_b32 v[42:43], v[164:165], v[164:165] op_sel:[0,0]
    s_waitcnt lgkmcnt(0)
    v_mfma_f32_32x32x16_bf16 v[44:59], v[124:127], v[4:7], v[12:27]
    s_mov_b32 s73, 4
    s_setprio 2
    s_nop 9
.p2align 6
a_loop:
    v_exp_f32 v44, v44
    v_cvt_pk_bf16_f32 v91, v74, v75
    v_exp_f32 v45, v45
    v_mfma_f32_32x32x16_bf16 v[60:75], v[124:127], v[8:11], v[28:43]
    ds_read_b128 v[124:127], v148 offset:4160
    v_exp_f32 v46, v46
    v_exp_f32 v47, v47
    v_cvt_pk_bf16_f32 v76, v44, v45
    v_exp_f32 v48, v48
    v_exp_f32 v49, v49
    v_cvt_pk_bf16_f32 v77, v46, v47
    v_mfma_f32_32x32x16_bf16 v[108:123], v[144:147], v[88:91], v[108:123]
    ds_read_b128 v[140:143], v149 offset:2080
    v_exp_f32 v50, v50
    v_exp_f32 v51, v51
    v_cvt_pk_bf16_f32 v78, v48, v49
    v_exp_f32 v52, v52
    v_exp_f32 v53, v53
    v_cvt_pk_bf16_f32 v79, v50, v51
    v_exp_f32 v54, v54
    v_exp_f32 v55, v55
    v_mfma_f32_32x32x16_bf16 v[92:107], v[132:135], v[76:79], v[92:107]
    ds_read_b128 v[144:147], v149 offset:2608
    v_cvt_pk_bf16_f32 v80, v52, v53
    v_exp_f32 v56, v56
    v_exp_f32 v57, v57
    v_cvt_pk_bf16_f32 v81, v54, v55
    v_exp_f32 v58, v58
    v_exp_f32 v59, v59
    v_cvt_pk_bf16_f32 v82, v56, v57
    v_exp_f32 v60, v60
    v_cvt_pk_bf16_f32 v83, v58, v59
    v_exp_f32 v61, v61
    v_mfma_f32_32x32x16_bf16 v[44:59], v[128:131], v[4:7], v[12:27]
    v_exp_f32 v62, v62
    v_exp_f32 v63, v63
    v_cvt_pk_bf16_f32 v84, v60, v61
    v_exp_f32 v64, v64
    v_exp_f32 v65, v65
    v_cvt_pk_bf16_f32 v85, v62, v63
    v_mfma_f32_32x32x16_bf16 v[92:107], v[136:139], v[80:83], v[92:107]
    s_waitcnt lgkmcnt(0)
    v_exp_f32 v66, v66
    v_exp_f32 v67, v67
    v_cvt_pk_bf16_f32 v86, v64, v65
    v_exp_f32 v68, v68
    v_exp_f32 v69, v69
    v_cvt_pk_bf16_f32 v87, v66, v67
    v_exp_f32 v70, v70
    v_exp_f32 v71, v71
    v_mfma_f32_32x32x16_bf16 v[108:123], v[132:135], v[84:87], v[108:123]
    v_cvt_pk_bf16_f32 v88, v68, v69
    v_exp_f32 v72, v72
    v_exp_f32 v73, v73
    v_cvt_pk_bf16_f32 v89, v70, v71
    v_exp_f32 v74, v74
    v_exp_f32 v75, v75
    v_cvt_pk_bf16_f32 v90, v72, v73
    v_exp_f32 v44, v44
    v_cvt_pk_bf16_f32 v91, v74, v75
    v_exp_f32 v45, v45
    v_mfma_f32_32x32x16_bf16 v[60:75], v[128:131], v[8:11], v[28:43]
    ds_read_b128 v[128:131], v148 offset:6240
    v_exp_f32 v46, v46
    v_exp_f32 v47, v47
    v_cvt_pk_bf16_f32 v76, v44, v45
    v_exp_f32 v48, v48
    v_exp_f32 v49, v49
    v_cvt_pk_bf16_f32 v77, v46, v47
    v_mfma_f32_32x32x16_bf16 v[108:123], v[136:139], v[88:91], v[108:123]
    ds_read_b128 v[132:135], v149 offset:4160
    v_exp_f32 v50, v50
    v_exp_f32 v51, v51
    v_cvt_pk_bf16_f32 v78, v48, v49
    v_exp_f32 v52, v52
    v_exp_f32 v53, v53
    v_cvt_pk_bf16_f32 v79, v50, v51
    v_exp_f32 v54, v54
    v_exp_f32 v55, v55
    v_mfma_f32_32x32x16_bf16 v[92:107], v[140:143], v[76:79], v[92:107]
    ds_read_b128 v[136:139], v149 offset:4688
    v_cvt_pk_bf16_f32 v80, v52, v53
    v_exp_f32 v56, v56
    v_exp_f32 v57, v57
    v_cvt_pk_bf16_f32 v81, v54, v55
    v_exp_f32 v58, v58
    v_exp_f32 v59, v59
    v_cvt_pk_bf16_f32 v82, v56, v57
    v_exp_f32 v60, v60
    v_cvt_pk_bf16_f32 v83, v58, v59
    v_exp_f32 v61, v61
    v_mfma_f32_32x32x16_bf16 v[44:59], v[124:127], v[4:7], v[12:27]
    v_exp_f32 v62, v62
    v_exp_f32 v63, v63
    v_cvt_pk_bf16_f32 v84, v60, v61
    v_exp_f32 v64, v64
    v_exp_f32 v65, v65
    v_cvt_pk_bf16_f32 v85, v62, v63
    v_mfma_f32_32x32x16_bf16 v[92:107], v[144:147], v[80:83], v[92:107]
    s_waitcnt lgkmcnt(0)
    v_exp_f32 v66, v66
    v_exp_f32 v67, v67
    v_cvt_pk_bf16_f32 v86, v64, v65
    v_exp_f32 v68, v68
    v_exp_f32 v69, v69
    v_cvt_pk_bf16_f32 v87, v66, v67
    v_exp_f32 v70, v70
    v_exp_f32 v71, v71
    v_mfma_f32_32x32x16_bf16 v[108:123], v[140:143], v[84:87], v[108:123]
    v_cvt_pk_bf16_f32 v88, v68, v69
    v_exp_f32 v72, v72
    v_exp_f32 v73, v73
    v_cvt_pk_bf16_f32 v89, v70, v71
    v_exp_f32 v74, v74
    v_exp_f32 v75, v75
    v_cvt_pk_bf16_f32 v90, v72, v73
    v_exp_f32 v44, v44
    v_cvt_pk_bf16_f32 v91, v74, v75
    v_exp_f32 v45, v45
    v_mfma_f32_32x32x16_bf16 v[60:75], v[124:127], v[8:11], v[28:43]
    ds_read_b128 v[124:127], v148 offset:8320
    v_exp_f32 v46, v46
    v_exp_f32 v47, v47
    v_cvt_pk_bf16_f32 v76, v44, v45
    v_exp_f32 v48, v48
    v_exp_f32 v49, v49
    v_cvt_pk_bf16_f32 v77, v46, v47
    v_mfma_f32_32x32x16_bf16 v[108:123], v[144:147], v[88:91], v[108:123]
    ds_read_b128 v[140:143], v149 offset:6240
    v_exp_f32 v50, v50
    v_exp_f32 v51, v51
    v_cvt_pk_bf16_f32 v78, v48, v49
    v_exp_f32 v52, v52
    v_exp_f32 v53, v53
    v_cvt_pk_bf16_f32 v79, v50, v51
    v_exp_f32 v54, v54
    v_exp_f32 v55, v55
    v_mfma_f32_32x32x16_bf16 v[92:107], v[132:135], v[76:79], v[92:107]
    ds_read_b128 v[144:147], v149 offset:6768
    v_cvt_pk_bf16_f32 v80, v52, v53
    v_exp_f32 v56, v56
    v_exp_f32 v57, v57
    v_cvt_pk_bf16_f32 v81, v54, v55
    v_exp_f32 v58, v58
    v_exp_f32 v59, v59
    v_cvt_pk_bf16_f32 v82, v56, v57
    v_exp_f32 v60, v60
    v_cvt_pk_bf16_f32 v83, v58, v59
    v_exp_f32 v61, v61
    v_mfma_f32_32x32x16_bf16 v[44:59], v[128:131], v[4:7], v[12:27]
    s_cmp_eq_u32 s73, 4
    v_exp_f32 v62, v62
    v_exp_f32 v63, v63
    v_cvt_pk_bf16_f32 v84, v60, v61
    v_exp_f32 v64, v64
    v_exp_f32 v65, v65
    v_cvt_pk_bf16_f32 v85, v62, v63
    v_mfma_f32_32x32x16_bf16 v[92:107], v[136:139], v[80:83], v[92:107]
    s_waitcnt lgkmcnt(0)
    v_exp_f32 v66, v66
    v_exp_f32 v67, v67
    v_cvt_pk_bf16_f32 v86, v64, v65
    v_exp_f32 v68, v68
    v_exp_f32 v69, v69
    v_cvt_pk_bf16_f32 v87, v66, v67
    v_exp_f32 v70, v70
    v_exp_f32 v71, v71
    v_mfma_f32_32x32x16_bf16 v[108:123], v[132:135], v[84:87], v[108:123]
    v_cvt_pk_bf16_f32 v88, v68, v69
    v_exp_f32 v72, v72
    v_exp_f32 v73, v73
    v_cvt_pk_bf16_f32 v89, v70, v71
    v_exp_f32 v74, v74
    v_exp_f32 v75, v75
    v_cvt_pk_bf16_f32 v90, v72, v73
    s_cbranch_scc1 a_chk1
a_ret1:
    v_exp_f32 v44, v44
    v_cvt_pk_bf16_f32 v91, v74, v75
    v_exp_f32 v45, v45
    v_mfma_f32_32x32x16_bf16 v[60:75], v[128:131], v[8:11], v[28:43]
    ds_read_b128 v[128:131], v148 offset:10400
    v_exp_f32 v46, v46
    v_exp_f32 v47, v47
    v_cvt_pk_bf16_f32 v76, v44, v45
    v_exp_f32 v48, v48
    v_exp_f32 v49, v49
    v_cvt_pk_bf16_f32 v77, v46, v47
    v_mfma_f32_32x32x16_bf16 v[108:123], v[136:139], v[88:91], v[108:123]
    ds_read_b128 v[132:135], v149 offset:8320
    v_exp_f32 v50, v50
    v_exp_f32 v51, v51
    v_cvt_pk_bf16_f32 v78, v48, v49
    v_exp_f32 v52, v52
    v_exp_f32 v53, v53
    v_cvt_pk_bf16_f32 v79, v50, v51
    v_exp_f32 v54, v54
    v_exp_f32 v55, v55
    v_mfma_f32_32x32x16_bf16 v[92:107], v[140:143], v[76:79], v[92:107]
    ds_read_b128 v[136:139], v149 offset:8848
    v_cvt_pk_bf16_f32 v80, v52, v53
    v_exp_f32 v56, v56
    v_exp_f32 v57, v57
    v_cvt_pk_bf16_f32 v81, v54, v55
    v_exp_f32 v58, v58
    v_exp_f32 v59, v59
    v_cvt_pk_bf16_f32 v82, v56, v57
    v_exp_f32 v60, v60
    v_cvt_pk_bf16_f32 v83, v58, v59
    v_exp_f32 v61, v61
    v_mfma_f32_32x32x16_bf16 v[44:59], v[124:127], v[4:7], v[12:27]
    v_exp_f32 v62, v62
    v_exp_f32 v63, v63
    v_cvt_pk_bf16_f32 v84, v60, v61
    v_exp_f32 v64, v64
    v_exp_f32 v65, v65
    v_cvt_pk_bf16_f32 v85, v62, v63
    v_mfma_f32_32x32x16_bf16 v[92:107], v[144:147], v[80:83], v[92:107]
    s_waitcnt lgkmcnt(0)
    v_exp_f32 v66, v66
    v_exp_f32 v67, v67
    v_cvt_pk_bf16_f32 v86, v64, v65
    v_exp_f32 v68, v68
    v_exp_f32 v69, v69
    v_cvt_pk_bf16_f32 v87, v66, v67
    v_exp_f32 v70, v70
    v_exp_f32 v71, v71
    v_mfma_f32_32x32x16_bf16 v[108:123], v[140:143], v[84:87], v[108:123]
    v_cvt_pk_bf16_f32 v88, v68, v69
    v_exp_f32 v72, v72
    v_exp_f32 v73, v73
    v_cvt_pk_bf16_f32 v89, v70, v71
    v_exp_f32 v74, v74
    v_exp_f32 v75, v75
    v_cvt_pk_bf16_f32 v90, v72, v73
    v_exp_f32 v44, v44
    v_cvt_pk_bf16_f32 v91, v74, v75
    v_exp_f32 v45, v45
    v_mfma_f32_32x32x16_bf16 v[60:75], v[124:127], v[8:11], v[28:43]
    ds_read_b128 v[124:127], v148 offset:12480
    v_exp_f32 v46, v46
    v_exp_f32 v47, v47
    v_cvt_pk_bf16_f32 v76, v44, v45
    v_exp_f32 v48, v48
    v_exp_f32 v49, v49
    v_cvt_pk_bf16_f32 v77, v46, v47
    v_mfma_f32_32x32x16_bf16 v[108:123], v[144:147], v[88:91], v[108:123]
    ds_read_b128 v[140:143], v149 offset:10400
    v_exp_f32 v50, v50
    v_exp_f32 v51, v51
    v_cvt_pk_bf16_f32 v78, v48, v49
    v_exp_f32 v52, v52
    v_exp_f32 v53, v53
    v_cvt_pk_bf16_f32 v79, v50, v51
    v_exp_f32 v54, v54
    v_exp_f32 v55, v55
    v_mfma_f32_32x32x16_bf16 v[92:107], v[132:135], v[76:79], v[92:107]
    ds_read_b128 v[144:147], v149 offset:10928
    v_cvt_pk_bf16_f32 v80, v52, v53
    v_exp_f32 v56, v56
    v_exp_f32 v57, v57
    v_cvt_pk_bf16_f32 v81, v54, v55
    v_exp_f32 v58, v58
    v_exp_f32 v59, v59
    v_cvt_pk_bf16_f32 v82, v56, v57
    v_exp_f32 v60, v60
    v_cvt_pk_bf16_f32 v83, v58, v59
    v_exp_f32 v61, v61
    v_mfma_f32_32x32x16_bf16 v[44:59], v[128:131], v[4:7], v[12:27]
    v_exp_f32 v62, v62
    v_exp_f32 v63, v63
    v_cvt_pk_bf16_f32 v84, v60, v61
    v_exp_f32 v64, v64
    v_exp_f32 v65, v65
    v_cvt_pk_bf16_f32 v85, v62, v63
    v_mfma_f32_32x32x16_bf16 v[92:107], v[136:139], v[80:83], v[92:107]
    s_waitcnt lgkmcnt(0)
    v_exp_f32 v66, v66
    v_exp_f32 v67, v67
    v_cvt_pk_bf16_f32 v86, v64, v65
    v_exp_f32 v68, v68
    v_exp_f32 v69, v69
    v_cvt_pk_bf16_f32 v87, v66, v67
    v_exp_f32 v70, v70
    v_exp_f32 v71, v71
    v_mfma_f32_32x32x16_bf16 v[108:123], v[132:135], v[84:87], v[108:123]
    v_cvt_pk_bf16_f32 v88, v68, v69
    v_exp_f32 v72, v72
    v_exp_f32 v73, v73
    v_cvt_pk_bf16_f32 v89, v70, v71
    v_exp_f32 v74, v74
    v_exp_f32 v75, v75
    v_cvt_pk_bf16_f32 v90, v72, v73
    v_exp_f32 v44, v44
    v_cvt_pk_bf16_f32 v91, v74, v75
    v_exp_f32 v45, v45
    v_mfma_f32_32x32x16_bf16 v[60:75], v[128:131], v[8:11], v[28:43]
    ds_read_b128 v[128:131], v148 offset:14560
    v_exp_f32 v46, v46
    v_exp_f32 v47, v47
    v_cvt_pk_bf16_f32 v76, v44, v45
    v_exp_f32 v48, v48
    v_exp_f32 v49, v49
    v_cvt_pk_bf16_f32 v77, v46, v47
    v_mfma_f32_32x32x16_bf16 v[108:123], v[136:139], v[88:91], v[108:123]
    ds_read_b128 v[132:135], v149 offset:12480
    v_exp_f32 v50, v50
    v_exp_f32 v51, v51
    v_cvt_pk_bf16_f32 v78, v48, v49
    v_exp_f32 v52, v52
    v_exp_f32 v53, v53
    v_cvt_pk_bf16_f32 v79, v50, v51
    v_exp_f32 v54, v54
    v_exp_f32 v55, v55
    v_mfma_f32_32x32x16_bf16 v[92:107], v[140:143], v[76:79], v[92:107]
    ds_read_b128 v[136:139], v149 offset:13008
    v_cvt_pk_bf16_f32 v80, v52, v53
    v_exp_f32 v56, v56
    v_exp_f32 v57, v57
    v_cvt_pk_bf16_f32 v81, v54, v55
    v_exp_f32 v58, v58
    v_exp_f32 v59, v59
    v_cvt_pk_bf16_f32 v82, v56, v57
    v_exp_f32 v60, v60
    v_cvt_pk_bf16_f32 v83, v58, v59
    v_exp_f32 v61, v61
    v_mfma_f32_32x32x16_bf16 v[44:59], v[124:127], v[4:7], v[12:27]
    v_exp_f32 v62, v62
    v_exp_f32 v63, v63
    v_cvt_pk_bf16_f32 v84, v60, v61
    v_exp_f32 v64, v64
    v_exp_f32 v65, v65
    v_cvt_pk_bf16_f32 v85, v62, v63
    v_mfma_f32_32x32x16_bf16 v[92:107], v[144:147], v[80:83], v[92:107]
    s_waitcnt lgkmcnt(0)
    v_exp_f32 v66, v66
    v_exp_f32 v67, v67
    v_cvt_pk_bf16_f32 v86, v64, v65
    v_exp_f32 v68, v68
    v_exp_f32 v69, v69
    v_cvt_pk_bf16_f32 v87, v66, v67
    v_exp_f32 v70, v70
    v_exp_f32 v71, v71
    v_mfma_f32_32x32x16_bf16 v[108:123], v[140:143], v[84:87], v[108:123]
    v_cvt_pk_bf16_f32 v88, v68, v69
    v_exp_f32 v72, v72
    v_exp_f32 v73, v73
    v_cvt_pk_bf16_f32 v89, v70, v71
    v_exp_f32 v74, v74
    v_exp_f32 v75, v75
    v_cvt_pk_bf16_f32 v90, v72, v73
    v_exp_f32 v44, v44
    v_cvt_pk_bf16_f32 v91, v74, v75
    v_exp_f32 v45, v45
    v_mfma_f32_32x32x16_bf16 v[60:75], v[124:127], v[8:11], v[28:43]
    ds_read_b128 v[124:127], v150 offset:0
    v_exp_f32 v46, v46
    v_exp_f32 v47, v47
    v_cvt_pk_bf16_f32 v76, v44, v45
    v_exp_f32 v48, v48
    v_exp_f32 v49, v49
    v_cvt_pk_bf16_f32 v77, v46, v47
    v_mfma_f32_32x32x16_bf16 v[108:123], v[144:147], v[88:91], v[108:123]
    ds_read_b128 v[140:143], v149 offset:14560
    v_exp_f32 v50, v50
    v_exp_f32 v51, v51
    v_cvt_pk_bf16_f32 v78, v48, v49
    v_exp_f32 v52, v52
    v_exp_f32 v53, v53
    v_cvt_pk_bf16_f32 v79, v50, v51
    v_exp_f32 v54, v54
    v_exp_f32 v55, v55
    v_mfma_f32_32x32x16_bf16 v[92:107], v[132:135], v[76:79], v[92:107]
    ds_read_b128 v[144:147], v149 offset:15088
    v_cvt_pk_bf16_f32 v80, v52, v53
    v_exp_f32 v56, v56
    v_exp_f32 v57, v57
    v_cvt_pk_bf16_f32 v81, v54, v55
    v_exp_f32 v58, v58
    v_exp_f32 v59, v59
    v_cvt_pk_bf16_f32 v82, v56, v57
    v_exp_f32 v60, v60
    v_cvt_pk_bf16_f32 v83, v58, v59
    v_exp_f32 v61, v61
    v_mfma_f32_32x32x16_bf16 v[44:59], v[128:131], v[4:7], v[12:27]
    s_sub_u32 s73, s73, 1
    v_exp_f32 v62, v62
    v_exp_f32 v63, v63
    v_cvt_pk_bf16_f32 v84, v60, v61
    v_exp_f32 v64, v64
    v_exp_f32 v65, v65
    v_cvt_pk_bf16_f32 v85, v62, v63
    v_mfma_f32_32x32x16_bf16 v[92:107], v[136:139], v[80:83], v[92:107]
    s_waitcnt lgkmcnt(0)
    v_exp_f32 v66, v66
    v_exp_f32 v67, v67
    v_cvt_pk_bf16_f32 v86, v64, v65
    v_exp_f32 v68, v68
    v_exp_f32 v69, v69
    v_cvt_pk_bf16_f32 v87, v66, v67
    v_exp_f32 v70, v70
    v_exp_f32 v71, v71
    v_mfma_f32_32x32x16_bf16 v[108:123], v[132:135], v[84:87], v[108:123]
    v_cvt_pk_bf16_f32 v88, v68, v69
    v_exp_f32 v72, v72
    v_exp_f32 v73, v73
    v_cvt_pk_bf16_f32 v89, v70, v71
    v_exp_f32 v74, v74
    v_exp_f32 v75, v75
    v_cvt_pk_bf16_f32 v90, v72, v73
    v_exp_f32 v44, v44
    v_cvt_pk_bf16_f32 v91, v74, v75
    v_exp_f32 v45, v45
    v_mfma_f32_32x32x16_bf16 v[60:75], v[128:131], v[8:11], v[28:43]
    ds_read_b128 v[128:131], v150 offset:2080
    v_exp_f32 v46, v46
    v_exp_f32 v47, v47
    v_cvt_pk_bf16_f32 v76, v44, v45
    v_exp_f32 v48, v48
    v_exp_f32 v49, v49
    v_cvt_pk_bf16_f32 v77, v46, v47
    v_mfma_f32_32x32x16_bf16 v[108:123], v[136:139], v[88:91], v[108:123]
    ds_read_b128 v[132:135], v151 offset:0
    v_exp_f32 v50, v50
    v_exp_f32 v51, v51
    v_cvt_pk_bf16_f32 v78, v48, v49
    v_exp_f32 v52, v52
    v_exp_f32 v53, v53
    v_cvt_pk_bf16_f32 v79, v50, v51
    v_exp_f32 v54, v54
    v_exp_f32 v55, v55
    v_mfma_f32_32x32x16_bf16 v[92:107], v[140:143], v[76:79], v[92:107]
    ds_read_b128 v[136:139], v151 offset:528
    v_cvt_pk_bf16_f32 v80, v52, v53
    v_exp_f32 v56, v56
    v_exp_f32 v57, v57
    v_cvt_pk_bf16_f32 v81, v54, v55
    v_exp_f32 v58, v58
    v_exp_f32 v59, v59
    v_cvt_pk_bf16_f32 v82, v56, v57
    v_exp_f32 v60, v60
    v_cvt_pk_bf16_f32 v83, v58, v59
    v_exp_f32 v61, v61
    v_mfma_f32_32x32x16_bf16 v[44:59], v[124:127], v[4:7], v[12:27]
    s_add_u32 s71, s71, 1
    v_exp_f32 v62, v62
    v_exp_f32 v63, v63
    v_cvt_pk_bf16_f32 v84, v60, v61
    v_exp_f32 v64, v64
    v_exp_f32 v65, v65
    v_cvt_pk_bf16_f32 v85, v62, v63
    v_mfma_f32_32x32x16_bf16 v[92:107], v[144:147], v[80:83], v[92:107]
    s_waitcnt lgkmcnt(0)
    v_exp_f32 v66, v66
    v_exp_f32 v67, v67
    v_cvt_pk_bf16_f32 v86, v64, v65
    v_exp_f32 v68, v68
    v_exp_f32 v69, v69
    v_cvt_pk_bf16_f32 v87, v66, v67
    v_exp_f32 v70, v70
    v_exp_f32 v71, v71
    v_mfma_f32_32x32x16_bf16 v[108:123], v[140:143], v[84:87], v[108:123]
    s_and_b32 s71, s71, 7
    v_cvt_pk_bf16_f32 v88, v68, v69
    v_exp_f32 v72, v72
    v_exp_f32 v73, v73
    v_cvt_pk_bf16_f32 v89, v70, v71
    v_exp_f32 v74, v74
    v_exp_f32 v75, v75
    s_mul_i32 s70, s71, 16640
    v_mov_b32 v148, v150
    v_mov_b32 v149, v151
    v_add_u32 v150, s70, v2
    v_add_u32 v151, s70, v152
    v_cvt_pk_bf16_f32 v90, v72, v73
    s_cmp_eq_u32 s73, 1
    s_cbranch_scc1 a_it2
    s_cmp_eq_u32 s73, 0
    s_cbranch_scc1 a_done
    s_cmp_eq_u32 s73, 3
    s_cbranch_scc0 a_it1
    s_waitcnt vmcnt(0)
    s_mov_b64 exec, 1
    ds_add_u32 v153, v155 offset:44
    s_mov_b64 exec, -1
    s_mov_b32 s75, 0x100000
lw12:
    ds_read_b32 v154, v153 offset:8
    s_sub_u32 s75, s75, 1
    s_waitcnt lgkmcnt(0)
    v_readfirstlane_b32 s74, v154
    s_nop 0
    s_cmp_ge_u32 s74, 4
    s_cbranch_scc1 lw12_ok
    s_sleep 1
    s_cmp_lg_u32 s75, 0
    s_cbranch_scc1 lw12
lw12_ok:
    s_branch a_loop
a_chk1:
    s_mov_b32 s75, 0x100000
lw13:
    ds_read_b32 v154, v153 offset:4
    s_sub_u32 s75, s75, 1
    s_waitcnt lgkmcnt(0)
    v_readfirstlane_b32 s74, v154
    s_nop 0
    s_cmp_ge_u32 s74, 4
    s_cbranch_scc1 lw13_ok
    s_sleep 1
    s_cmp_lg_u32 s75, 0
    s_cbranch_scc1 lw13
lw13_ok:
    s_branch a_ret1
a_it1:
    s_mov_b64 exec, 1
    ds_add_u32 v153, v155 offset:12
    s_mov_b64 exec, -1
    s_mov_b32 s75, 0x100000
lw14:
    ds_read_b32 v154, v153 offset:60
    s_sub_u32 s75, s75, 1
    s_waitcnt lgkmcnt(0)
    v_readfirstlane_b32 s74, v154
    s_nop 0
    s_cmp_ge_u32 s74, 4
    s_cbranch_scc1 lw14_ok
    s_sleep 1
    s_cmp_lg_u32 s75, 0
    s_cbranch_scc1 lw14
lw14_ok:
    s_setprio 1
    s_branch a_loop
a_it2:
    s_and_b32 s66, s3, 1
    s_lshr_b32 s67, s3, 1
    s_lshl_b32 s63, s66, 5
    s_add_u32 s63, s63, s56
    v_and_b32 v159, 31, v1
    v_add_u32 v159, s63, v159
    v_lshlrev_b32 v158, 3, v3
    v_lshl_add_u32 v158, v159, 10, v158
    v_lshlrev_b32 v159, 2, v159
    s_lshl_b32 s69, s67, 5
    s_lshl_b32 s63, s57, 1
    s_add_u32 s69, s69, s63
    buffer_load_dwordx2 v[160:161], v158, s[36:39], s69 offen
    buffer_load_dwordx2 v[162:163], v158, s[36:39], s69 offen offset:16
    v_lshl_add_u32 v158, v3, 3, v158
    s_cmp_lt_u32 s3, 3
    s_cselect_b32 s63, 0, 1600
    s_mul_i32 s64, s3, 2304
    s_add_u32 s63, s63, s64
    s_add_u32 s63, s63, 141312
    v_add_u32 v156, s63, v2
    v_lshl_add_u32 v166, v1, 2, s63
    s_xor_b32 s65, s3, 4
    s_cmp_lt_u32 s65, 3
    s_cselect_b32 s63, 0, 1600
    s_mul_i32 s64, s65, 2304
    s_add_u32 s63, s63, s64
    s_add_u32 s63, s63, 141312
    v_add_u32 v157, s63, v2
    v_lshl_add_u32 v167, v1, 2, s63
    s_lshl_b32 s68, s60, 1
    s_add_u32 s68, s68, s66
    s_lshl_b32 s68, s68, 5
    s_lshl_b32 s63, s67, 3
    s_add_u32 s68, s68, s63
    s_lshl_b32 s68, s68, 10
    s_add_u32 s68, s68, 3145728
    s_add_u32 s59, s68, 4096
    s_lshl_b32 s63, s67, 1
    s_and_b32 s63, s63, 4
    s_add_u32 s63, s63, s58
    s_and_b32 s63, s63, 7
    s_mul_i32 s63, s63, 16640
    s_and_b32 s64, s67, 1
    s_lshl_b32 s64, s64, 14
    s_add_u32 s63, s63, s64
    v_bfe_u32 v165, v1, 2, 2
    v_lshrrev_b32 v164, 1, v165
    v_lshl_add_u32 v165, v3, 2, v165
    v_lshlrev_b32 v165, 7, v165
    v_bfe_u32 v154, v1, 4, 1
    v_lshl_add_u32 v165, v154, 5, v165
    v_and_b32 v154, 3, v1
    v_lshl_add_u32 v165, v154, 3, v165
    v_lshl_add_u32 v164, v164, 6, v165
    v_add_u32 v164, s63, v164
    s_lshl_b32 s63, s67, 11
    s_lshl_b32 s64, s66, 6
    s_add_u32 s63, s63, s64
    s_add_u32 s63, s63, 133120
    v_add_u32 v165, s63, v165
    s_lshl_b32 s63, s66, 2
    s_add_u32 s63, s63, s58
    s_add_u32 s63, s63, 2
    s_and_b32 s63, s63, 7
    s_mul_i32 s72, s63, 16640
    s_mov_b32 s76, 151552
    ds_read_b32 v154, v153 offset:56
    s_waitcnt lgkmcnt(0)
    v_readfirstlane_b32 s77, v154
    s_setprio 0
    s_cmp_lt_u32 s3, 4
    s_cbranch_scc1 a_loop
    s_mov_b32 s75, 0x100000
lw15:
    ds_read_b32 v154, v153 offset:20
    s_sub_u32 s75, s75, 1
    s_waitcnt lgkmcnt(0)
    v_readfirstlane_b32 s74, v154
    s_nop 0
    s_cmp_ge_u32 s74, 4
    s_cbranch_scc1 lw15_ok
    s_sleep 2
    s_cmp_lg_u32 s75, 0
    s_cbranch_scc1 lw15
lw15_ok:
    s_branch a_loop
a_done:
    v_cvt_pk_bf16_f32 v91, v74, v75
    s_cmp_ge_u32 s3, 4
    s_nop 0
    v_mfma_f32_32x32x16_bf16 v[108:123], v[144:147], v[88:91], v[108:123]
    s_cbranch_scc1 a_red1
    v_lshlrev_b32 v10, 6, v1
    s_lshl_b32 s63, s61, 11
    v_add_u32 v10, s63, v10
    s_lshl_b32 s63, s60, 6
    s_mov_b32 exec_lo, 0
    v_and_b32 v10, 7, v1
    v_lshlrev_b32 v10, 11, v10
    v_add_u32 v10, s63, v10
    s_mov_b32 exec_lo, -1
    s_mov_b32 s73, 196608
    s_mov_b32 s75, 262144
    v_lshrrev_b32 v7, 3, v1
    v_and_b32 v8, 7, v1
    v_lshlrev_b32 v8, 4, v8
    v_lshl_add_u32 v8, v7, 12, v8
    s_lshl_b32 s64, s3, 4
    s_add_u32 s64, s64, s57
    s_lshl_b32 s64, s64, 12
    s_lshl_b32 s63, s56, 1
    s_add_u32 s64, s64, s63
    s_add_u32 s64, s64, 5242880
    s_add_u32 s65, s64, 32768
    s_lshl_b32 s63, s3, 11
    s_add_u32 s63, s63, 133120
    v_add_u32 v7, s63, v2
a_ypoll:
    buffer_load_dwordx2 v[20:21], v10, s[32:35], s73 offen sc1
    s_sub_u32 s75, s75, 1
    s_waitcnt vmcnt(0)
    v_cmp_ne_u32 vcc, s77, v20
    s_cbranch_vccz a_yready
    s_sleep 4
    s_cmp_lg_u32 s75, 0
    s_cbranch_scc1 a_ypoll
a_yready:
    buffer_load_dwordx4 v[12:15], v8, s[32:35], s64 offen sc1
    buffer_load_dwordx4 v[16:19], v8, s[32:35], s65 offen sc1
    s_getreg_b32 s63, hwreg(HW_REG_XCC_ID)
    v_cmp_ne_u32 vcc, s63, v21
    s_nop 0
    s_cmp_eq_u32 vcc_hi, 0
    s_cselect_b32 s63, 1, 0
    v_mov_b32 v11, s63
    ds_write_b32 v153, v11 offset:48
    s_waitcnt vmcnt(1)
    ds_write_b128 v7, v[12:15]
    s_waitcnt vmcnt(0)
    ds_write_b128 v7, v[16:19] offset:1024
    ds_write_b128 v156, v[108:111]
    ds_write_b128 v156, v[112:115] offset:1024
    ds_write_b32 v166, v116 offset:2048
    v_xor_b32 v9, 64, v164
    s_mov_b32 s75, 0x40000
    s_waitcnt lgkmcnt(0)
    s_barrier
    ds_read_b32 v10, v153 offset:48
    ds_read_b32 v52, v167 offset:2048
    ds_read_b128 v[44:47], v157
    ds_read_b128 v[48:51], v157 offset:1024
    ds_read_b64_tr_b16 v[148:149], v165
    ds_read_b64_tr_b16 v[150:151], v165 offset:1024
    s_waitcnt lgkmcnt(4)
    buffer_load_dword v152, v159, s[32:35], s76 offen sc1
    v_readfirstlane_b32 s63, v10
    v_add_f32 v100, v100, v52
    v_rcp_f32 v154, v100
    s_waitcnt lgkmcnt(2)
    v_add_f32 v92, v92, v44
    v_add_f32 v93, v93, v45
    v_add_f32 v94, v94, v46
    v_add_f32 v95, v95, v47
    v_add_f32 v96, v96, v48
    v_add_f32 v97, v97, v49
    v_add_f32 v98, v98, v50
    v_add_f32 v99, v99, v51
    v_mul_f32 v92, v92, v154
    v_mul_f32 v93, v93, v154
    v_mul_f32 v94, v94, v154
    v_mul_f32 v95, v95, v154
    v_mul_f32 v96, v96, v154
    v_mul_f32 v97, v97, v154
    v_mul_f32 v98, v98, v154
    v_mul_f32 v99, v99, v154
    v_cvt_pk_bf16_f32 v4, v92, v93
    v_cvt_pk_bf16_f32 v5, v94, v95
    v_cvt_pk_bf16_f32 v6, v96, v97
    v_cvt_pk_bf16_f32 v7, v98, v99
    s_branch a_p3
a_red1:
    ds_write_b128 v156, v[92:95]
    ds_write_b128 v156, v[96:99] offset:1024
    ds_write_b32 v166, v100 offset:2048
    v_xor_b32 v9, 64, v164
    s_mov_b32 s75, 0x40000
    s_waitcnt lgkmcnt(0)
    s_barrier
    ds_read_b32 v10, v153 offset:48
    ds_read_b32 v52, v167 offset:2048
    ds_read_b128 v[44:47], v157
    ds_read_b128 v[48:51], v157 offset:1024
    ds_read_b64_tr_b16 v[148:149], v165
    ds_read_b64_tr_b16 v[150:151], v165 offset:1024
    s_waitcnt lgkmcnt(4)
    buffer_load_dword v152, v159, s[32:35], s76 offen sc1
    v_readfirstlane_b32 s63, v10
    v_add_f32 v116, v116, v52
    v_rcp_f32 v154, v116
    s_waitcnt lgkmcnt(2)
    v_add_f32 v108, v108, v44
    v_add_f32 v109, v109, v45
    v_add_f32 v110, v110, v46
    v_add_f32 v111, v111, v47
    v_add_f32 v112, v112, v48
    v_add_f32 v113, v113, v49
    v_add_f32 v114, v114, v50
    v_add_f32 v115, v115, v51
    v_mul_f32 v108, v108, v154
    v_mul_f32 v109, v109, v154
    v_mul_f32 v110, v110, v154
    v_mul_f32 v111, v111, v154
    v_mul_f32 v112, v112, v154
    v_mul_f32 v113, v113, v154
    v_mul_f32 v114, v114, v154
    v_mul_f32 v115, v115, v154
    v_cvt_pk_bf16_f32 v4, v108, v109
    v_cvt_pk_bf16_f32 v5, v110, v111
    v_cvt_pk_bf16_f32 v6, v112, v113
    v_cvt_pk_bf16_f32 v7, v114, v115
a_p3:
    s_cmp_eq_u32 s63, 1
    s_cbranch_scc1 a_olocal
    buffer_store_dwordx4 v[4:7], v2, s[32:35], s62 offen sc1
    s_branch a_ostored
a_olocal:
    buffer_store_dwordx4 v[4:7], v2, s[32:35], s62 offen nt
a_ostored:
    ds_read_b64_tr_b16 v[44:45], v164 offset:0
    ds_read_b64_tr_b16 v[46:47], v164 offset:1024
    ds_read_b64_tr_b16 v[48:49], v9 offset:0
    ds_read_b64_tr_b16 v[50:51], v9 offset:1024
    ds_read_b64_tr_b16 v[52:53], v164 offset:2048
    ds_read_b64_tr_b16 v[54:55], v164 offset:3072
    ds_read_b64_tr_b16 v[56:57], v9 offset:2048
    ds_read_b64_tr_b16 v[58:59], v9 offset:3072
    ds_read_b64_tr_b16 v[60:61], v164 offset:4096
    ds_read_b64_tr_b16 v[62:63], v164 offset:5120
    ds_read_b64_tr_b16 v[64:65], v9 offset:4096
    ds_read_b64_tr_b16 v[66:67], v9 offset:5120
    s_waitcnt lgkmcnt(6)
    ds_read_b64_tr_b16 v[68:69], v164 offset:6144
    ds_read_b64_tr_b16 v[70:71], v164 offset:7168
    ds_read_b64_tr_b16 v[72:73], v9 offset:6144
    ds_read_b64_tr_b16 v[74:75], v9 offset:7168
    ds_read_b64_tr_b16 v[76:77], v164 offset:8192
    ds_read_b64_tr_b16 v[78:79], v164 offset:9216
    ds_read_b64_tr_b16 v[80:81], v9 offset:8192
    ds_read_b64_tr_b16 v[82:83], v9 offset:9216
    s_waitcnt lgkmcnt(6)
    ds_read_b64_tr_b16 v[84:85], v164 offset:10240
    ds_read_b64_tr_b16 v[86:87], v164 offset:11264
    ds_read_b64_tr_b16 v[88:89], v9 offset:10240
    ds_read_b64_tr_b16 v[90:91], v9 offset:11264
    ds_read_b64_tr_b16 v[92:93], v164 offset:12288
    ds_read_b64_tr_b16 v[94:95], v164 offset:13312
    ds_read_b64_tr_b16 v[96:97], v9 offset:12288
    ds_read_b64_tr_b16 v[98:99], v9 offset:13312
    s_waitcnt lgkmcnt(6)
    ds_read_b64_tr_b16 v[100:101], v164 offset:14336
    ds_read_b64_tr_b16 v[102:103], v164 offset:15360
    ds_read_b64_tr_b16 v[104:105], v9 offset:14336
    ds_read_b64_tr_b16 v[106:107], v9 offset:15360
    buffer_load_dwordx4 v[12:15], v2, s[32:35], s68 offen offset:0 sc1
    buffer_load_dwordx4 v[16:19], v2, s[32:35], s68 offen offset:1024 sc1
    buffer_load_dwordx4 v[20:23], v2, s[32:35], s68 offen offset:2048 sc1
    buffer_load_dwordx4 v[24:27], v2, s[32:35], s68 offen offset:3072 sc1
    buffer_load_dwordx4 v[28:31], v2, s[32:35], s59 offen offset:0 sc1
    buffer_load_dwordx4 v[32:35], v2, s[32:35], s59 offen offset:1024 sc1
    buffer_load_dwordx4 v[36:39], v2, s[32:35], s59 offen offset:2048 sc1
    buffer_load_dwordx4 v[40:43], v2, s[32:35], s59 offen offset:3072 sc1
    s_waitcnt vmcnt(9)
    v_sub_f32 v153, 1.0, v152
    v_lshlrev_b32 v140, 16, v160
    v_and_b32 v141, 0xffff0000, v160
    v_lshlrev_b32 v142, 16, v161
    v_and_b32 v143, 0xffff0000, v161
    v_lshlrev_b32 v154, 16, v148
    v_and_b32 v155, 0xffff0000, v148
    v_lshlrev_b32 v156, 16, v149
    v_and_b32 v157, 0xffff0000, v149
    v_mul_f32 v140, v140, v154
    v_mul_f32 v141, v141, v155
    v_mul_f32 v142, v142, v156
    v_mul_f32 v143, v143, v157
    v_mul_f32 v140, v140, v152
    v_mul_f32 v141, v141, v152
    v_mul_f32 v142, v142, v152
    v_mul_f32 v143, v143, v152
    v_lshlrev_b32 v144, 16, v162
    v_and_b32 v145, 0xffff0000, v162
    v_lshlrev_b32 v146, 16, v163
    v_and_b32 v147, 0xffff0000, v163
    v_lshlrev_b32 v154, 16, v150
    v_and_b32 v155, 0xffff0000, v150
    v_lshlrev_b32 v156, 16, v151
    v_and_b32 v157, 0xffff0000, v151
    v_mul_f32 v144, v144, v154
    v_mul_f32 v145, v145, v155
    v_mul_f32 v146, v146, v156
    v_mul_f32 v147, v147, v157
    v_mul_f32 v144, v144, v152
    v_mul_f32 v145, v145, v152
    v_mul_f32 v146, v146, v152
    v_mul_f32 v147, v147, v152
    s_lshl_b32 s63, s67, 11
    s_add_u32 s63, s63, s72
    v_add_u32 v8, s63, v2
    s_lshl_b32 s63, s67, 13
    s_add_u32 s63, s63, s72
    v_add_u32 v11, s63, v2
    s_waitcnt lgkmcnt(0)
    s_waitcnt vmcnt(7)
a_ochk0:
    v_max3_u32 v10, v12, v13, v14
    v_max_u32 v10, v10, v15
    v_cmp_eq_u32 vcc, -1, v10
    s_cbranch_vccnz a_oretry0
a_ogo0:
    v_mfma_f32_32x32x16_bf16 v[108:123], v[44:47], v[12:15], 0
    v_mfma_f32_32x32x16_bf16 v[124:139], v[48:51], v[12:15], 0
    s_waitcnt vmcnt(6)
a_ochk1:
    v_max3_u32 v10, v16, v17, v18
    v_max_u32 v10, v10, v19
    v_cmp_eq_u32 vcc, -1, v10
    s_cbranch_vccnz a_oretry1
a_ogo1:
    v_mfma_f32_32x32x16_bf16 v[108:123], v[52:55], v[16:19], v[108:123]
    v_mfma_f32_32x32x16_bf16 v[124:139], v[56:59], v[16:19], v[124:139]
    s_waitcnt vmcnt(5)
a_ochk2:
    v_max3_u32 v10, v20, v21, v22
    v_max_u32 v10, v10, v23
    v_cmp_eq_u32 vcc, -1, v10
    s_cbranch_vccnz a_oretry2
a_ogo2:
    v_mfma_f32_32x32x16_bf16 v[108:123], v[60:63], v[20:23], v[108:123]
    v_mfma_f32_32x32x16_bf16 v[124:139], v[64:67], v[20:23], v[124:139]
    s_waitcnt vmcnt(4)
a_ochk3:
    v_max3_u32 v10, v24, v25, v26
    v_max_u32 v10, v10, v27
    v_cmp_eq_u32 vcc, -1, v10
    s_cbranch_vccnz a_oretry3
a_ogo3:
    v_mfma_f32_32x32x16_bf16 v[108:123], v[68:71], v[24:27], v[108:123]
    v_mfma_f32_32x32x16_bf16 v[124:139], v[72:75], v[24:27], v[124:139]
    s_waitcnt vmcnt(3)
a_ochk4:
    v_max3_u32 v10, v28, v29, v30
    v_max_u32 v10, v10, v31
    v_cmp_eq_u32 vcc, -1, v10
    s_cbranch_vccnz a_oretry4
a_ogo4:
    v_mfma_f32_32x32x16_bf16 v[108:123], v[76:79], v[28:31], v[108:123]
    v_mfma_f32_32x32x16_bf16 v[124:139], v[80:83], v[28:31], v[124:139]
    s_waitcnt vmcnt(2)
a_ochk5:
    v_max3_u32 v10, v32, v33, v34
    v_max_u32 v10, v10, v35
    v_cmp_eq_u32 vcc, -1, v10
    s_cbranch_vccnz a_oretry5
a_ogo5:
    v_mfma_f32_32x32x16_bf16 v[108:123], v[84:87], v[32:35], v[108:123]
    v_mfma_f32_32x32x16_bf16 v[124:139], v[88:91], v[32:35], v[124:139]
    s_waitcnt vmcnt(1)
a_ochk6:
    v_max3_u32 v10, v36, v37, v38
    v_max_u32 v10, v10, v39
    v_cmp_eq_u32 vcc, -1, v10
    s_cbranch_vccnz a_oretry6
a_ogo6:
    v_mfma_f32_32x32x16_bf16 v[108:123], v[92:95], v[36:39], v[108:123]
    v_mfma_f32_32x32x16_bf16 v[124:139], v[96:99], v[36:39], v[124:139]
    s_waitcnt vmcnt(0)
a_ochk7:
    v_max3_u32 v10, v40, v41, v42
    v_max_u32 v10, v10, v43
    v_cmp_eq_u32 vcc, -1, v10
    s_cbranch_vccnz a_oretry7
a_ogo7:
    v_mfma_f32_32x32x16_bf16 v[108:123], v[100:103], v[40:43], v[108:123]
    v_mfma_f32_32x32x16_bf16 v[124:139], v[104:107], v[40:43], v[124:139]
    s_nop 10
    ds_write_b128 v8, v[108:111] offset:0
    ds_write_b128 v8, v[112:115] offset:1024
    ds_write_b128 v8, v[116:119] offset:8192
    ds_write_b128 v8, v[120:123] offset:9216
    ds_write_b128 v8, v[124:127] offset:16384
    ds_write_b128 v8, v[128:131] offset:17408
    ds_write_b128 v8, v[132:135] offset:24576
    ds_write_b128 v8, v[136:139] offset:25600
    s_waitcnt lgkmcnt(0)
    s_barrier
    ds_read_b128 v[12:15], v11 offset:0
    ds_read_b128 v[16:19], v11 offset:1024
    ds_read_b128 v[20:23], v11 offset:2048
    ds_read_b128 v[24:27], v11 offset:3072
    ds_read_b128 v[28:31], v11 offset:4096
    ds_read_b128 v[32:35], v11 offset:5120
    ds_read_b128 v[36:39], v11 offset:6144
    ds_read_b128 v[40:43], v11 offset:7168
    s_waitcnt lgkmcnt(4)
    v_add_f32 v12, v12, v20
    v_add_f32 v13, v13, v21
    v_add_f32 v14, v14, v22
    v_add_f32 v15, v15, v23
    v_add_f32 v16, v16, v24
    v_add_f32 v17, v17, v25
    v_add_f32 v18, v18, v26
    v_add_f32 v19, v19, v27
    s_waitcnt lgkmcnt(0)
    v_add_f32 v28, v28, v36
    v_add_f32 v29, v29, v37
    v_add_f32 v30, v30, v38
    v_add_f32 v31, v31, v39
    v_add_f32 v32, v32, v40
    v_add_f32 v33, v33, v41
    v_add_f32 v34, v34, v42
    v_add_f32 v35, v35, v43
    v_add_f32 v12, v12, v28
    v_add_f32 v13, v13, v29
    v_add_f32 v14, v14, v30
    v_add_f32 v15, v15, v31
    v_add_f32 v16, v16, v32
    v_add_f32 v17, v17, v33
    v_add_f32 v18, v18, v34
    v_add_f32 v19, v19, v35
    v_fmac_f32 v140, v12, v153
    v_fmac_f32 v141, v13, v153
    v_fmac_f32 v142, v14, v153
    v_fmac_f32 v143, v15, v153
    v_fmac_f32 v144, v16, v153
    v_fmac_f32 v145, v17, v153
    v_fmac_f32 v146, v18, v153
    v_fmac_f32 v147, v19, v153
    v_cvt_pk_bf16_f32 v12, v140, v141
    v_cvt_pk_bf16_f32 v13, v142, v143
    v_cvt_pk_bf16_f32 v14, v144, v145
    v_cvt_pk_bf16_f32 v15, v146, v147
    s_nop 0
    v_permlane32_swap_b32 v12, v14
    v_permlane32_swap_b32 v13, v15
    buffer_store_dwordx4 v[12:15], v158, s[40:43], s69 offen
    s_endpgm
a_oretry0:
    s_waitcnt vmcnt(0)
    buffer_load_dwordx4 v[12:15], v2, s[32:35], s68 offen offset:0 sc1
    buffer_load_dwordx4 v[16:19], v2, s[32:35], s68 offen offset:1024 sc1
    buffer_load_dwordx4 v[20:23], v2, s[32:35], s68 offen offset:2048 sc1
    buffer_load_dwordx4 v[24:27], v2, s[32:35], s68 offen offset:3072 sc1
    buffer_load_dwordx4 v[28:31], v2, s[32:35], s59 offen offset:0 sc1
    buffer_load_dwordx4 v[32:35], v2, s[32:35], s59 offen offset:1024 sc1
    buffer_load_dwordx4 v[36:39], v2, s[32:35], s59 offen offset:2048 sc1
    buffer_load_dwordx4 v[40:43], v2, s[32:35], s59 offen offset:3072 sc1
    s_sub_u32 s75, s75, 1
    s_waitcnt vmcnt(7)
    s_cmp_lg_u32 s75, 0
    s_cbranch_scc1 a_ochk0
    s_branch a_ogo0
a_oretry1:
    s_waitcnt vmcnt(0)
    buffer_load_dwordx4 v[16:19], v2, s[32:35], s68 offen offset:1024 sc1
    buffer_load_dwordx4 v[20:23], v2, s[32:35], s68 offen offset:2048 sc1
    buffer_load_dwordx4 v[24:27], v2, s[32:35], s68 offen offset:3072 sc1
    buffer_load_dwordx4 v[28:31], v2, s[32:35], s59 offen offset:0 sc1
    buffer_load_dwordx4 v[32:35], v2, s[32:35], s59 offen offset:1024 sc1
    buffer_load_dwordx4 v[36:39], v2, s[32:35], s59 offen offset:2048 sc1
    buffer_load_dwordx4 v[40:43], v2, s[32:35], s59 offen offset:3072 sc1
    s_sub_u32 s75, s75, 1
    s_waitcnt vmcnt(6)
    s_cmp_lg_u32 s75, 0
    s_cbranch_scc1 a_ochk1
    s_branch a_ogo1
a_oretry2:
    s_waitcnt vmcnt(0)
    buffer_load_dwordx4 v[20:23], v2, s[32:35], s68 offen offset:2048 sc1
    buffer_load_dwordx4 v[24:27], v2, s[32:35], s68 offen offset:3072 sc1
    buffer_load_dwordx4 v[28:31], v2, s[32:35], s59 offen offset:0 sc1
    buffer_load_dwordx4 v[32:35], v2, s[32:35], s59 offen offset:1024 sc1
    buffer_load_dwordx4 v[36:39], v2, s[32:35], s59 offen offset:2048 sc1
    buffer_load_dwordx4 v[40:43], v2, s[32:35], s59 offen offset:3072 sc1
    s_sub_u32 s75, s75, 1
    s_waitcnt vmcnt(5)
    s_cmp_lg_u32 s75, 0
    s_cbranch_scc1 a_ochk2
    s_branch a_ogo2
a_oretry3:
    s_waitcnt vmcnt(0)
    buffer_load_dwordx4 v[24:27], v2, s[32:35], s68 offen offset:3072 sc1
    buffer_load_dwordx4 v[28:31], v2, s[32:35], s59 offen offset:0 sc1
    buffer_load_dwordx4 v[32:35], v2, s[32:35], s59 offen offset:1024 sc1
    buffer_load_dwordx4 v[36:39], v2, s[32:35], s59 offen offset:2048 sc1
    buffer_load_dwordx4 v[40:43], v2, s[32:35], s59 offen offset:3072 sc1
    s_sub_u32 s75, s75, 1
    s_waitcnt vmcnt(4)
    s_cmp_lg_u32 s75, 0
    s_cbranch_scc1 a_ochk3
    s_branch a_ogo3
a_oretry4:
    s_waitcnt vmcnt(0)
    buffer_load_dwordx4 v[28:31], v2, s[32:35], s59 offen offset:0 sc1
    buffer_load_dwordx4 v[32:35], v2, s[32:35], s59 offen offset:1024 sc1
    buffer_load_dwordx4 v[36:39], v2, s[32:35], s59 offen offset:2048 sc1
    buffer_load_dwordx4 v[40:43], v2, s[32:35], s59 offen offset:3072 sc1
    s_sub_u32 s75, s75, 1
    s_waitcnt vmcnt(3)
    s_cmp_lg_u32 s75, 0
    s_cbranch_scc1 a_ochk4
    s_branch a_ogo4
a_oretry5:
    s_waitcnt vmcnt(0)
    buffer_load_dwordx4 v[32:35], v2, s[32:35], s59 offen offset:1024 sc1
    buffer_load_dwordx4 v[36:39], v2, s[32:35], s59 offen offset:2048 sc1
    buffer_load_dwordx4 v[40:43], v2, s[32:35], s59 offen offset:3072 sc1
    s_sub_u32 s75, s75, 1
    s_waitcnt vmcnt(2)
    s_cmp_lg_u32 s75, 0
    s_cbranch_scc1 a_ochk5
    s_branch a_ogo5
a_oretry6:
    s_waitcnt vmcnt(0)
    buffer_load_dwordx4 v[36:39], v2, s[32:35], s59 offen offset:2048 sc1
    buffer_load_dwordx4 v[40:43], v2, s[32:35], s59 offen offset:3072 sc1
    s_sub_u32 s75, s75, 1
    s_waitcnt vmcnt(1)
    s_cmp_lg_u32 s75, 0
    s_cbranch_scc1 a_ochk6
    s_branch a_ogo6
a_oretry7:
    s_waitcnt vmcnt(0)
    buffer_load_dwordx4 v[40:43], v2, s[32:35], s59 offen offset:3072 sc1
    s_sub_u32 s75, s75, 1
    s_waitcnt vmcnt(0)
    s_cmp_lg_u32 s75, 0
    s_cbranch_scc1 a_ochk7
    s_branch a_ogo7
k_end:
    s_endpgm
code_end:
.section .rodata,"a"
.p2align 6
.amdhsa_kernel gated_mix__ssm_conv_h3__grouped_kv_mqa__prompt_kernel
  .amdhsa_next_free_vgpr 168
  .amdhsa_next_free_sgpr 80
  .amdhsa_accum_offset 168
  .amdhsa_group_segment_fixed_size 0
  .amdhsa_kernarg_size 120
  .amdhsa_user_sgpr_count 2
  .amdhsa_user_sgpr_kernarg_segment_ptr 1
  .amdhsa_system_sgpr_workgroup_id_x 1
.end_amdhsa_kernel
```
